```python
import torch

def _softmax(x, axis=-1):
    return torch.softmax(x, dim=axis)
def _gelu(x):
    return torch.nn.functional.gelu(x, approximate="tanh")
def _silu(x):
    return torch.nn.functional.silu(x)
def _sigmoid(x):
    return torch.sigmoid(x)
def _layernorm(x, axis=-1, eps=1e-5):
    m = x.mean(dim=axis, keepdim=True)
    v = x.var(dim=axis, keepdim=True, unbiased=False)
    return (x - m) / torch.sqrt(v + eps)
def _scatter_add(tgt, idx, src, axis=0):
    return tgt.clone().index_add_(axis, idx, src)
def _segment_sum(src, seg, n):
    out = torch.zeros((n,) + src.shape[1:], dtype=src.dtype)
    return out.index_add_(0, seg, src)
def _pad(x, pw):
    flat = tuple(v for pair in reversed(pw) for v in pair)
    return torch.nn.functional.pad(x, flat)

kernel_name = 'parallel_sum__ssm_conv_s4__dense_activation_squared_relu__prompt'

def setup_inputs():

    _w = (lambda a: (lambda t: t.to(torch.bfloat16) if t.is_floating_point() else t)(torch.as_tensor(a)))
    def _A_setup():
        B, L, D, N = 1, 2048, 448, 256
        A_re = -(lambda _x: torch.exp(torch.as_tensor(_x)))((lambda *s: torch.randn(*s, dtype=torch.bfloat16) * 3.2)(D, N))
        A_im = torch.pi * (lambda *s: torch.randn(*s, dtype=torch.bfloat16) * 0.2)(D, N)
        B_re = (lambda *s: torch.randn(*s, dtype=torch.bfloat16) * 0.4)(D, N)
        B_im = (lambda *s: torch.randn(*s, dtype=torch.bfloat16) * 0.4)(D, N)
        C_re = (lambda *s: torch.randn(*s, dtype=torch.bfloat16) * 0.4)(D, N)
        C_im = (lambda *s: torch.randn(*s, dtype=torch.bfloat16) * 0.4)(D, N)
        log_dt = (lambda *s: torch.randn(*s, dtype=torch.bfloat16) * 0.2)(D) * 0.5 - 4.0
        Dskip = (lambda *s: torch.randn(*s, dtype=torch.bfloat16) * 0.4)(D)
        return {
            "u": _w((lambda *s: torch.randn(*s, dtype=torch.bfloat16) * 0.05)(B, L, D)),
            "A_re": _w(A_re),
            "A_im": _w(A_im),
            "B_re": _w(B_re),
            "B_im": _w(B_im),
            "C_re": _w(C_re),
            "C_im": _w(C_im),
            "log_dt": _w(log_dt),
            "Dskip": _w(Dskip),
        }
    _A_in = _A_setup()

    def _B_setup():
        B, S, D, F = 1, 2048, 448, 1792
        return {
            "x": _w((lambda *s: torch.randn(*s, dtype=torch.bfloat16) * 0.05)(B, S, D)),
            "w1": _w((lambda *s: torch.randn(*s, dtype=torch.bfloat16) * 0.05)(D, F)),
            "b1": _w((lambda *s: torch.randn(*s, dtype=torch.bfloat16) * 0.2)(F)),
            "w2": _w((lambda *s: torch.randn(*s, dtype=torch.bfloat16) * 0.05)(F, D)),
            "b2": _w((lambda *s: torch.randn(*s, dtype=torch.bfloat16) * 0.8)(D)),
        }
    _B_in = _B_setup()

    return {
        "A_u": _A_in["u"],
        "A_A_re": _A_in["A_re"],
        "A_A_im": _A_in["A_im"],
        "A_B_re": _A_in["B_re"],
        "A_B_im": _A_in["B_im"],
        "A_C_re": _A_in["C_re"],
        "A_C_im": _A_in["C_im"],
        "A_log_dt": _A_in["log_dt"],
        "A_Dskip": _A_in["Dskip"],
        "B_x": _B_in["x"],
        "B_w1": _B_in["w1"],
        "B_b1": _B_in["b1"],
        "B_w2": _B_in["w2"],
        "B_b2": _B_in["b2"],
    }

def reference(A_u, A_A_re, A_A_im, A_B_re, A_B_im, A_C_re, A_C_im, A_log_dt, A_Dskip, B_x, B_w1, B_b1, B_w2, B_b2):
    def _A_ref(u, A_re, A_im, B_re, B_im, C_re, C_im, log_dt, Dskip):
        Bsz, L, D = u.shape
        dt = torch.exp(log_dt)[:, None]
        A = A_re + 1j * A_im
        Bc = B_re + 1j * B_im
        Cc = C_re + 1j * C_im
        logdA = dt * A
        dB = dt * Bc
        l = (lambda x, dt: x.to(dt))(torch.arange(L), A_re.dtype)
        P = torch.exp(logdA[:, :, None] * l[None, None, :])
        K = torch.einsum("dn,dnl,dn->dl", Cc, P, dB).real
        L2 = 2 * L
        Kp = _pad(K, ((0, 0), (0, L)))
        up = (lambda x, *d: x.permute(*d))(u, 0, 2, 1)
        up = _pad(up, ((0, 0), (0, 0), (0, L)))
        Kf = (lambda x, axes=(-2,-1): torch.fft.rfft2(x.float(), dim=axes))(Kp[:, None, :], axes=(-2, -1))
        Uf = (lambda x, axes=(-2,-1): torch.fft.rfft2(x.float(), dim=axes))(up[:, :, None, :], axes=(-2, -1))
        Yf = Uf * Kf[None, :, :, :]
        y = (lambda x, s, axes=(-2,-1): torch.fft.irfft2(x, s=s, dim=axes).to(torch.bfloat16))(Yf, (1, L2), axes=(-2, -1))[:, :, 0, :L]
        y = (lambda x, *d: x.permute(*d))(y, 0, 2, 1) + u * Dskip[None, None, :]
        return y

    def _B_ref(x, w1, b1, w2, b2):
        h = torch.einsum("bsd,df->bsf", x, w1) + b1
        zero = torch.zeros_like(h)
        r = torch.where(h > zero, h, zero)
        h = r * r
        out = torch.einsum("bsf,fd->bsd", h, w2) + b2
        return out

    x = A_u
    xn = _layernorm(x, axis=-1)
    return x + _A_ref(xn, A_A_re, A_A_im, A_B_re, A_B_im, A_C_re, A_C_im, A_log_dt, A_Dskip) + _B_ref(xn, B_w1, B_b1, B_w2, B_b2)
```

```asm
; @launch grid=(256,1,1) block=(512,1,1) lds=163840
.amdgcn_target "amdgcn-amd-amdhsa--gfx950"
.text
.globl parallel_sum__ssm_conv_s4__dense_activation_squared_relu__prompt_kernel
.p2align 8
.type parallel_sum__ssm_conv_s4__dense_activation_squared_relu__prompt_kernel,@function
parallel_sum__ssm_conv_s4__dense_activation_squared_relu__prompt_kernel:
    s_cmp_ge_u32 s2, 256
    s_cbranch_scc1 L_end
    s_load_dwordx16 s[16:31], s[0:1], 0
    s_load_dwordx16 s[32:47], s[0:1], 64
    s_load_dwordx2 s[48:49], s[0:1], 128
    v_lshrrev_b32 v1, 6, v0
    v_and_b32 v0, 63, v0
    v_readfirstlane_b32 s3, v1
    s_and_b32 s4, s2, 7
    s_lshr_b32 s5, s2, 3
    s_and_b32 s7, s3, 3
    s_mov_b32 s100, 0
    s_cmp_lt_u32 s3, 4
    s_cbranch_scc1 L_G
    s_cmp_lg_u32 s7, 3
    s_cbranch_scc1 Lt_1
    s_getpc_b64 s[8:9]
L_pc:
    s_lshl_b32 s11, s5, 10
    v_and_b32 v3, 7, v0
    v_lshl_add_u32 v3, v3, 7, s11
    v_min_u32 v3, L_end-L_pc, v3
    global_load_dword v255, v3, s[8:9]
Lt_1:
    s_cmp_lg_u32 s7, 0
    s_cbranch_scc1 Lz_2
    v_lshlrev_b32 v30, 1, v0
    v_add_u32 v30, 157696, v30
    v_mov_b32 v31, 0
    ds_write_b16 v30, v31
Lz_2:
    s_mul_i32 s14, s4, 28
    s_add_u32 s14, s14, s5
    s_lshl_b32 s8, s14, 2
    s_add_u32 s9, s8, s7
    s_lshl_b32 s9, s9, 8
    v_lshl_add_u32 v3, v0, 2, s9
    s_cmp_ge_u32 s5, 28
    s_cbranch_scc1 L_SH
    s_waitcnt lgkmcnt(0)
    global_load_dword v12, v3, s[18:19] nt
    global_load_dword v13, v3, s[20:21] nt
    global_load_dword v14, v3, s[22:23] nt
    global_load_dword v15, v3, s[24:25] nt
    global_load_dword v16, v3, s[26:27] nt
    global_load_dword v17, v3, s[28:29] nt
    s_load_dword s15, s[30:31], s8
    s_load_dword s50, s[32:33], s8
    s_load_dword s101, s[42:43], s8
    s_branch L_S
L_G:
    s_lshl_b32 s96, s4, 5
    s_add_u32 s96, s96, s5
    s_lshl_b32 s97, s96, 2
    s_add_u32 s95, s97, s7
    s_mul_i32 s97, s95, 1792
    v_lshrrev_b32 v80, 5, v0
    v_and_b32 v81, 31, v0
    v_mul_u32_u24 v82, 896, v80
    v_lshl_add_u32 v82, v81, 4, v82
    v_add_u32 v83, 512, v82
    v_cmp_gt_u32 vcc, 24, v81
    v_mov_b32 v84, 0x40000000
    s_nop 0
    v_cndmask_b32 v83, v84, v83, vcc
    s_mov_b64 s[98:99], vcc
    s_waitcnt lgkmcnt(0)
    s_mov_b32 s52, s16
    s_and_b32 s53, s17, 0xffff
    s_mov_b32 s54, 1835008
    s_mov_b32 s55, 0x20000
    buffer_load_dwordx4 v[64:67], v82, s[52:55], s97 offen
    buffer_load_dwordx4 v[68:71], v83, s[52:55], s97 offen
    s_load_dword s6, s[48:49], 0
    s_setprio 2
    s_cmp_ge_u32 s5, 28
    s_cbranch_scc1 L_GH
    s_mul_i32 s8, s5, 9363
    s_lshr_b32 s8, s8, 16
    s_mul_i32 s9, s8, 7
    s_sub_u32 s51, s5, s9
    s_lshr_b32 s10, s4, 1
    s_lshl_b32 s10, s10, 2
    s_add_u32 s10, s10, s8
    s_and_b32 s11, s4, 1
    s_mul_i32 s11, s11, 7
    s_add_u32 s11, s11, s51
    s_lshl_b32 s12, s10, 2
    s_add_u32 s12, s12, s7
    s_mul_i32 s12, s12, 28672
    s_lshl_b32 s15, s7, 12
    v_lshrrev_b32 v16, 3, v0
    v_and_b32 v17, 7, v0
    v_lshrrev_b32 v18, 1, v16
    v_xor_b32 v18, v18, v17
    v_mul_u32_u24 v19, 896, v16
    v_lshl_add_u32 v4, v18, 4, v19
    v_xor_b32 v20, 4, v18
    v_lshl_add_u32 v5, v20, 4, v19
    v_add_u32 v5, 6144, v5
    v_add_u32 v6, 12288, v4
    v_add_u32 v7, 12288, v5
    s_add_u32 m0, s15, 0
    s_nop 0
    buffer_load_dwordx4 v4, s[52:55], s12 offen offset:0 lds
    buffer_load_dwordx4 v5, s[52:55], s12 offen offset:1024 lds
    buffer_load_dwordx4 v6, s[52:55], s12 offen offset:2048 lds
    buffer_load_dwordx4 v7, s[52:55], s12 offen offset:3072 lds
    s_mul_i32 s13, s7, 57344
    s_lshl_b32 s8, s11, 8
    s_add_u32 s13, s13, s8
    v_lshrrev_b32 v20, 4, v0
    v_and_b32 v21, 15, v0
    v_lshlrev_b32 v22, 2, v20
    v_xor_b32 v22, v22, v21
    v_mul_u32_u24 v23, 3584, v20
    v_lshl_add_u32 v8, v22, 4, v23
    v_add_u32 v9, 13312, v8
    v_add_u32 v10, 26624, v8
    v_add_u32 v11, 39936, v8
    s_mov_b32 s56, s36
    s_and_b32 s57, s37, 0xffff
    s_mov_b32 s58, 1605632
    s_mov_b32 s59, 0x20000
    s_add_u32 m0, s15, 16384
    s_nop 0
    buffer_load_dwordx4 v8, s[56:59], s13 offen offset:0 lds
    buffer_load_dwordx4 v9, s[56:59], s13 offen offset:1024 lds
    buffer_load_dwordx4 v10, s[56:59], s13 offen offset:2048 lds
    buffer_load_dwordx4 v11, s[56:59], s13 offen offset:3072 lds
    v_lshlrev_b32 v1, 2, v0
    v_add_u32 v1, 158848, v1
    v_mov_b32 v2, 157696
    v_cmp_eq_u32 vcc, 0, v0
    s_nop 1
    v_cndmask_b32 v1, v1, v2, vcc
    v_mov_b32 v2, 1
    v_and_b32 v22, 1, v20
    v_lshlrev_b32 v22, 2, v22
    v_xor_b32 v22, v22, v17
    v_lshl_add_u32 v12, v22, 4, v19
    v_add_u32 v13, 6144, v12
    v_add_u32 v14, 12288, v12
    v_add_u32 v15, 18432, v12
    v_bfe_u32 v16, v0, 2, 2
    v_and_b32 v17, 3, v0
    v_lshrrev_b32 v20, 5, v0
    v_bfe_u32 v18, v0, 4, 1
    v_lshlrev_b32 v18, 5, v18
    v_lshl_add_u32 v18, v17, 3, v18
    v_lshl_add_u32 v19, v20, 3, v16
    v_lshl_add_u32 v19, v19, 8, v18
    s_and_b32 s9, s7, 1
    s_lshl_b32 s8, s9, 1
    v_xor_b32 v22, s8, v16
    v_lshl_add_u32 v36, v22, 6, v19
    v_xor_b32 v37, 64, v36
    v_add_u32 v38, 0x10000, v36
    v_add_u32 v39, 0x10000, v37
    v_lshl_add_u32 v19, v20, 2, v16
    v_lshl_add_u32 v19, v19, 7, v18
    v_add_u32 v19, s15, v19
    v_lshrrev_b32 v22, 1, v16
    v_xor_b32 v22, s9, v22
    v_lshl_add_u32 v48, v22, 6, v19
    v_xor_b32 v49, 64, v48
    v_add_u32 v50, 0x10000, v48
    v_add_u32 v51, 0x10000, v49
    v_and_b32 v21, 31, v0
    v_bfe_u32 v22, v0, 1, 3
    v_xor_b32 v22, v22, v20
    v_lshlrev_b32 v23, 7, v21
    s_lshr_b32 s8, s7, 1
    s_lshl_b32 s8, s8, 13
    v_add_u32 v23, s8, v23
    v_lshl_add_u32 v40, v22, 4, v23
    v_xor_b32 v41, 32, v40
    v_xor_b32 v42, 64, v40
    v_xor_b32 v43, 96, v40
    v_add_u32 v44, 0x10000, v40
    v_add_u32 v45, 0x10000, v41
    v_add_u32 v46, 0x10000, v42
    v_add_u32 v47, 0x10000, v43
    s_mul_i32 s50, s5, 9363
    s_lshr_b32 s50, s50, 16
    s_mul_i32 s8, s50, 7
    s_sub_u32 s51, s5, s8
    s_lshl_b32 s8, s4, 2
    s_add_u32 s50, s50, s8
    s_lshl_b32 s50, s50, 1
    s_mov_b32 s60, s40
    s_and_b32 s61, s41, 0xffff
    s_mov_b32 s62, 1605632
    s_mov_b32 s63, 0x20000
    s_mul_i32 s14, s7, 401408
    s_lshl_b32 s8, s51, 7
    s_add_u32 s14, s14, s8
    s_add_u32 s14, s14, 172032
    s_lshl_b32 s24, s11, 1
    s_and_b32 s9, s7, 1
    s_add_u32 s24, s24, s9
    s_lshl_b32 s8, s24, 7
    v_lshl_add_u32 v16, v0, 1, s8
    global_load_ushort v25, v16, s[38:39]
    s_lshl_b32 s25, s10, 1
    s_lshr_b32 s9, s7, 1
    s_add_u32 s25, s25, s9
    s_lshl_b32 s27, s25, 9
    s_add_u32 s27, s27, 16384
    s_lshl_b32 s26, s24, 9
    s_add_u32 s26, s26, 32768
    v_lshlrev_b32 v17, 3, v0
    v_lshlrev_b32 v18, 3, v21
    v_lshlrev_b32 v16, 4, v0
    s_mul_i32 s22, s25, 230912
    s_mul_i32 s8, s24, 4096
    s_add_u32 s22, s22, s8
    s_add_u32 s22, s22, 6291456
    s_add_u32 s23, s22, 115456
    s_lshl_b32 s46, s51, 2
    s_add_u32 s46, s46, s7
    s_mul_i32 s21, s46, 896
    s_add_u32 s21, s21, 458752
    v_min_u32 v19, 6, v0
    v_lshlrev_b32 v19, 7, v19
    s_lshl_b32 s46, s46, 7
    s_add_u32 s46, s46, 3145728
    s_and_b32 s8, s7, 1
    s_mul_i32 s8, s8, 28672
    s_sub_u32 s9, 28672, s8
    v_lshrrev_b32 v33, 3, v0
    v_mul_u32_u24 v33, 3584, v33
    v_and_b32 v34, 7, v0
    v_lshl_add_u32 v33, v34, 4, v33
    v_add_u32 v34, s9, v33
    v_add_u32 v33, s8, v33
    s_mov_b32 s64, s48
    s_and_b32 s65, s49, 0xffff
    s_mov_b32 s66, 33554432
    s_mov_b32 s67, 0x20000
    v_mov_b32 v85, 0x3f803f80
    v_mov_b32 v86, 0x00003f80
    v_mov_b32 v87, 0x3f800000
    s_mul_i32 s8, s7, 1920
    s_add_u32 s8, s8, 148480
    v_mul_u32_u24 v82, 960, v80
    v_lshl_add_u32 v82, v81, 4, v82
    v_add_u32 v82, s8, v82
    v_lshlrev_b32 v80, 3, v80
    v_bfe_u32 v84, v0, 2, 2
    v_mul_u32_u24 v83, 960, v84
    v_lshrrev_b32 v84, 4, v0
    v_lshl_add_u32 v83, v84, 5, v83
    v_and_b32 v84, 3, v0
    v_lshl_add_u32 v83, v84, 3, v83
    s_lshl_b32 s8, s7, 7
    s_add_u32 s8, s8, 148480
    v_add_u32 v83, s8, v83
    v_lshrrev_b32 v81, 3, v0
    v_lshlrev_b32 v81, 15, v81
    v_and_b32 v84, 7, v0
    v_lshl_add_u32 v81, v84, 4, v81
    s_lshl_b32 s95, s95, 4
    s_add_u32 s95, s95, 16384
    s_lshl_b32 s97, s7, 18
    s_lshl_b32 s9, s96, 7
    s_add_u32 s97, s97, s9
    s_add_u32 s97, s97, 1048576
    s_add_u32 s28, s97, 1048576
    s_cmp_eq_u32 s7, 3
    s_cselect_b32 s28, 33554432, s28
    s_lshl_b32 s96, s96, 2
    s_lshl_b32 s8, s7, 10
    s_add_u32 s96, s96, s8
    s_add_u32 s29, s96, 393216
    s_waitcnt lgkmcnt(0)
    s_add_u32 s6, s6, 2654435769
    v_min_u32 v22, 1, v0
    v_lshlrev_b32 v22, 30, v22
    v_mov_b32 v23, s6
    v_mov_b32 v93, v23
    ds_write_b32 v1, v23 offset:128
    s_waitcnt vmcnt(9)
    v_dot2_f32_bf16 v88, v64, v85, 0
    v_dot2_f32_bf16 v89, v64, v64, 0
    v_dot2_f32_bf16 v88, v65, v85, v88
    v_dot2_f32_bf16 v89, v65, v65, v89
    s_add_u32 m0, s15, 32768
    s_add_u32 s12, s12, 128
    buffer_load_dwordx4 v4, s[52:55], s12 offen offset:0 lds
    v_dot2_f32_bf16 v88, v66, v85, v88
    v_dot2_f32_bf16 v89, v66, v66, v89
    v_dot2_f32_bf16 v88, v67, v85, v88
    v_dot2_f32_bf16 v89, v67, v67, v89
    buffer_load_dwordx4 v5, s[52:55], s12 offen offset:1024 lds
    v_dot2_f32_bf16 v88, v68, v85, v88
    v_dot2_f32_bf16 v89, v68, v68, v89
    v_dot2_f32_bf16 v88, v69, v85, v88
    v_dot2_f32_bf16 v89, v69, v69, v89
    buffer_load_dwordx4 v6, s[52:55], s12 offen offset:2048 lds
    v_dot2_f32_bf16 v88, v70, v85, v88
    v_dot2_f32_bf16 v89, v70, v70, v89
    v_dot2_f32_bf16 v88, v71, v85, v88
    v_dot2_f32_bf16 v89, v71, v71, v89
    buffer_load_dwordx4 v7, s[52:55], s12 offen offset:3072 lds
    s_nop 0
    v_add_f32_dpp v88, v88, v88 row_ror:8 row_mask:0xf bank_mask:0xf
    v_add_f32_dpp v89, v89, v89 row_ror:8 row_mask:0xf bank_mask:0xf
    s_nop 0
    v_add_f32_dpp v88, v88, v88 row_ror:4 row_mask:0xf bank_mask:0xf
    v_add_f32_dpp v89, v89, v89 row_ror:4 row_mask:0xf bank_mask:0xf
    s_nop 0
    v_add_f32_dpp v88, v88, v88 row_ror:2 row_mask:0xf bank_mask:0xf
    v_add_f32_dpp v89, v89, v89 row_ror:2 row_mask:0xf bank_mask:0xf
    s_nop 0
    v_add_f32_dpp v88, v88, v88 row_ror:1 row_mask:0xf bank_mask:0xf
    v_add_f32_dpp v89, v89, v89 row_ror:1 row_mask:0xf bank_mask:0xf
    v_mov_b32 v90, v88
    v_mov_b32 v91, v89
    s_add_u32 m0, s15, 49152
    s_add_u32 s13, s13, 229376
    buffer_load_dwordx4 v8, s[56:59], s13 offen offset:0 lds
    v_permlane16_swap_b32 v88, v90
    v_permlane16_swap_b32 v89, v91
    v_add_f32 v88, v88, v90
    v_add_f32 v89, v89, v91
    v_mul_f32 v88, 0xbb124925, v88
    v_mul_f32 v89, 0x3b124925, v89
    v_fma_f32 v89, -v88, v88, v89
    v_cvt_pk_bf16_f32 v88, v88, v88
    v_and_b32 v88, 0xffff0000, v88
    v_max_f32 v89, 0, v89
    v_dot2_f32_bf16 v96, v64, v86, v88
    v_dot2_f32_bf16 v97, v64, v87, v88
    v_cvt_pk_bf16_f32 v89, v89, v89
    v_dot2_f32_bf16 v98, v65, v86, v88
    v_dot2_f32_bf16 v99, v65, v87, v88
    v_and_b32 v89, 0xffff0000, v89
    buffer_load_dwordx4 v9, s[56:59], s13 offen offset:1024 lds
    v_dot2_f32_bf16 v100, v66, v86, v88
    v_dot2_f32_bf16 v101, v66, v87, v88
    v_add_f32 v89, 0x3727c5ac, v89
    v_dot2_f32_bf16 v102, v67, v86, v88
    v_dot2_f32_bf16 v103, v67, v87, v88
    v_cvt_pk_bf16_f32 v89, v89, v89
    buffer_load_dwordx4 v10, s[56:59], s13 offen offset:2048 lds
    v_dot2_f32_bf16 v104, v68, v86, v88
    v_dot2_f32_bf16 v105, v68, v87, v88
    v_and_b32 v89, 0xffff0000, v89
    v_dot2_f32_bf16 v106, v69, v86, v88
    v_dot2_f32_bf16 v107, v69, v87, v88
    v_sqrt_f32 v89, v89
    buffer_load_dwordx4 v11, s[56:59], s13 offen offset:3072 lds
    v_dot2_f32_bf16 v108, v70, v86, v88
    v_dot2_f32_bf16 v109, v70, v87, v88
    v_cvt_pk_bf16_f32 v89, v89, v89
    v_dot2_f32_bf16 v110, v71, v86, v88
    v_dot2_f32_bf16 v111, v71, v87, v88
    v_and_b32 v89, 0xffff0000, v89
    s_add_u32 m0, s15, 65536
    s_add_u32 s12, s12, 128
    buffer_load_dwordx4 v4, s[52:55], s12 offen offset:0 lds
    v_rcp_f32 v90, v89
    v_cvt_pk_bf16_f32 v92, v88, v89
    s_mov_b32 exec_lo, 1
    s_mov_b32 exec_hi, 1
    buffer_store_dwordx2 v[92:93], v80, s[64:67], s95 offen sc1
    s_mov_b64 exec, -1
    v_cvt_pk_bf16_f32 v64, v96, v97
    v_cvt_pk_bf16_f32 v65, v98, v99
    v_cvt_pk_bf16_f32 v66, v100, v101
    v_cvt_pk_bf16_f32 v67, v102, v103
    v_cvt_pk_bf16_f32 v68, v104, v105
    v_cvt_pk_bf16_f32 v69, v106, v107
    v_cvt_pk_bf16_f32 v70, v108, v109
    v_cvt_pk_bf16_f32 v71, v110, v111
    v_lshlrev_b32 v96, 16, v64
    v_and_b32 v97, 0xffff0000, v64
    v_mul_f32 v96, v90, v96
    v_mul_f32 v97, v90, v97
    v_cvt_pk_bf16_f32 v64, v96, v97
    buffer_load_dwordx4 v5, s[52:55], s12 offen offset:1024 lds
    v_lshlrev_b32 v98, 16, v65
    v_and_b32 v99, 0xffff0000, v65
    v_mul_f32 v98, v90, v98
    v_mul_f32 v99, v90, v99
    v_cvt_pk_bf16_f32 v65, v98, v99
    buffer_load_dwordx4 v6, s[52:55], s12 offen offset:2048 lds
    v_lshlrev_b32 v100, 16, v66
    v_and_b32 v101, 0xffff0000, v66
    v_mul_f32 v100, v90, v100
    v_mul_f32 v101, v90, v101
    v_cvt_pk_bf16_f32 v66, v100, v101
    buffer_load_dwordx4 v7, s[52:55], s12 offen offset:3072 lds
    v_lshlrev_b32 v102, 16, v67
    v_and_b32 v103, 0xffff0000, v67
    v_mul_f32 v102, v90, v102
    v_mul_f32 v103, v90, v103
    v_cvt_pk_bf16_f32 v67, v102, v103
    ds_write_b128 v82, v[64:67]
    v_lshlrev_b32 v104, 16, v68
    v_and_b32 v105, 0xffff0000, v68
    v_mul_f32 v104, v90, v104
    v_mul_f32 v105, v90, v105
    v_cvt_pk_bf16_f32 v68, v104, v105
    v_lshlrev_b32 v106, 16, v69
    v_and_b32 v107, 0xffff0000, v69
    v_mul_f32 v106, v90, v106
    v_mul_f32 v107, v90, v107
    v_cvt_pk_bf16_f32 v69, v106, v107
    v_lshlrev_b32 v108, 16, v70
    v_and_b32 v109, 0xffff0000, v70
    v_mul_f32 v108, v90, v108
    v_mul_f32 v109, v90, v109
    v_cvt_pk_bf16_f32 v70, v108, v109
    v_lshlrev_b32 v110, 16, v71
    v_and_b32 v111, 0xffff0000, v71
    v_mul_f32 v110, v90, v110
    v_mul_f32 v111, v90, v111
    v_cvt_pk_bf16_f32 v71, v110, v111
    s_mov_b64 exec, s[98:99]
    ds_write_b128 v82, v[68:71] offset:512
    s_mov_b64 exec, -1
    s_waitcnt vmcnt(14)
    s_waitcnt lgkmcnt(0)
    s_barrier
    ds_read_b64_tr_b16 v[224:225], v83
    ds_read_b64_tr_b16 v[226:227], v83 offset:3840
    ds_read_b64_tr_b16 v[228:229], v83 offset:512
    ds_read_b64_tr_b16 v[230:231], v83 offset:4352
    v_mov_b32 v232, v81
    ds_read_b64_tr_b16 v[128:129], v36 offset:16384
    ds_read_b64_tr_b16 v[130:131], v36 offset:17408
    ds_read_b128 v[136:139], v40 offset:0
    ds_read_b64_tr_b16 v[132:133], v37 offset:16384
    ds_read_b64_tr_b16 v[134:135], v37 offset:17408
    ds_read_b128 v[140:143], v40 offset:4096
    ds_read_b64_tr_b16 v[144:145], v36 offset:20480
    ds_read_b64_tr_b16 v[146:147], v36 offset:21504
    ds_read_b128 v[152:155], v41 offset:0
    ds_read_b64_tr_b16 v[148:149], v37 offset:20480
    ds_read_b64_tr_b16 v[150:151], v37 offset:21504
    ds_read_b128 v[156:159], v41 offset:4096
    s_waitcnt lgkmcnt(14)
    buffer_store_dwordx4 v[224:227], v232, s[64:67], s97 offen sc1
    s_waitcnt lgkmcnt(12)
    buffer_store_dwordx4 v[228:231], v232, s[64:67], s28 offen sc1
    s_waitcnt lgkmcnt(9)
    v_mfma_f32_32x32x16_bf16 v[64:79], v[128:131], v[136:139], 0
    s_add_u32 m0, s15, 81920
    s_add_u32 s13, s13, 229376
    buffer_load_dwordx4 v8, s[56:59], s13 offen offset:0 lds
    ds_read_b64_tr_b16 v[160:161], v36 offset:24576
    ds_read_b64_tr_b16 v[162:163], v36 offset:25600
    s_waitcnt lgkmcnt(9)
    v_mfma_f32_32x32x16_bf16 v[96:111], v[132:135], v[136:139], 0
    buffer_load_dwordx4 v9, s[56:59], s13 offen offset:1024 lds
    ds_read_b128 v[168:171], v42 offset:0
    ds_read_b64_tr_b16 v[164:165], v37 offset:24576
    s_waitcnt lgkmcnt(10)
    v_mfma_f32_32x32x16_bf16 v[80:95], v[128:131], v[140:143], 0
    buffer_load_dwordx4 v10, s[56:59], s13 offen offset:2048 lds
    ds_read_b64_tr_b16 v[166:167], v37 offset:25600
    ds_read_b128 v[172:175], v42 offset:4096
    v_mfma_f32_32x32x16_bf16 v[112:127], v[132:135], v[140:143], 0
    buffer_load_dwordx4 v11, s[56:59], s13 offen offset:3072 lds
    ds_read_b64_tr_b16 v[176:177], v36 offset:28672
    ds_read_b64_tr_b16 v[178:179], v36 offset:29696
    s_waitcnt lgkmcnt(11)
    v_mfma_f32_32x32x16_bf16 v[64:79], v[144:147], v[152:155], v[64:79]
    s_add_u32 m0, s15, 98304
    s_add_u32 s12, s12, 128
    buffer_load_dwordx4 v4, s[52:55], s12 offen offset:0 lds
    ds_read_b128 v[184:187], v43 offset:0
    ds_read_b64_tr_b16 v[180:181], v37 offset:28672
    s_waitcnt lgkmcnt(11)
    v_mfma_f32_32x32x16_bf16 v[96:111], v[148:151], v[152:155], v[96:111]
    buffer_load_dwordx4 v5, s[52:55], s12 offen offset:1024 lds
    ds_read_b64_tr_b16 v[182:183], v37 offset:29696
    ds_read_b128 v[188:191], v43 offset:4096
    s_waitcnt lgkmcnt(12)
    v_mfma_f32_32x32x16_bf16 v[80:95], v[144:147], v[156:159], v[80:95]
    buffer_load_dwordx4 v6, s[52:55], s12 offen offset:2048 lds
    v_mfma_f32_32x32x16_bf16 v[112:127], v[148:151], v[156:159], v[112:127]
    buffer_load_dwordx4 v7, s[52:55], s12 offen offset:3072 lds
    s_waitcnt lgkmcnt(9)
    v_mfma_f32_32x32x16_bf16 v[64:79], v[160:163], v[168:171], v[64:79]
    s_waitcnt vmcnt(15)
    s_waitcnt lgkmcnt(0)
    s_barrier
    v_mfma_f32_32x32x16_bf16 v[96:111], v[164:167], v[168:171], v[96:111]
    s_add_u32 m0, s15, 0
    s_add_u32 s13, s13, 229376
    buffer_load_dwordx4 v8, s[56:59], s13 offen offset:0 lds
    ds_read_b64_tr_b16 v[128:129], v36 offset:49152
    v_mfma_f32_32x32x16_bf16 v[80:95], v[160:163], v[172:175], v[80:95]
    s_waitcnt vmcnt(9)
    buffer_store_dword v23, v22, s[64:67], s29 offen sc1
    ds_read_b64_tr_b16 v[130:131], v36 offset:50176
    ds_read_b128 v[136:139], v40 offset:32768
    ds_read_b64_tr_b16 v[132:133], v37 offset:49152
    v_mfma_f32_32x32x16_bf16 v[112:127], v[164:167], v[172:175], v[112:127]
    buffer_load_dwordx4 v9, s[56:59], s13 offen offset:1024 lds
    ds_read_b64_tr_b16 v[134:135], v37 offset:50176
    v_mfma_f32_32x32x16_bf16 v[64:79], v[176:179], v[184:187], v[64:79]
    ds_read_b128 v[140:143], v40 offset:36864
    ds_read_b64_tr_b16 v[144:145], v36 offset:53248
    ds_read_b64_tr_b16 v[146:147], v36 offset:54272
    v_mfma_f32_32x32x16_bf16 v[96:111], v[180:183], v[184:187], v[96:111]
    buffer_load_dwordx4 v10, s[56:59], s13 offen offset:2048 lds
    ds_read_b128 v[152:155], v41 offset:32768
    v_mfma_f32_32x32x16_bf16 v[80:95], v[176:179], v[188:191], v[80:95]
    ds_read_b64_tr_b16 v[148:149], v37 offset:53248
    ds_read_b64_tr_b16 v[150:151], v37 offset:54272
    v_mfma_f32_32x32x16_bf16 v[112:127], v[180:183], v[188:191], v[112:127]
    buffer_load_dwordx4 v11, s[56:59], s13 offen offset:3072 lds
    ds_read_b128 v[156:159], v41 offset:36864
    s_waitcnt lgkmcnt(9)
    v_mfma_f32_32x32x16_bf16 v[64:79], v[128:131], v[136:139], v[64:79]
    ds_read_b64_tr_b16 v[160:161], v36 offset:57344
    ds_read_b64_tr_b16 v[162:163], v36 offset:58368
    s_waitcnt lgkmcnt(9)
    v_mfma_f32_32x32x16_bf16 v[96:111], v[132:135], v[136:139], v[96:111]
    s_add_u32 m0, s15, 16384
    s_add_u32 s12, s12, 128
    buffer_load_dwordx4 v4, s[52:55], s12 offen offset:0 lds
    ds_read_b128 v[168:171], v42 offset:32768
    s_waitcnt lgkmcnt(9)
    v_mfma_f32_32x32x16_bf16 v[80:95], v[128:131], v[140:143], v[80:95]
    ds_read_b64_tr_b16 v[164:165], v37 offset:57344
    ds_read_b64_tr_b16 v[166:167], v37 offset:58368
    ds_read_b128 v[172:175], v42 offset:36864
    v_mfma_f32_32x32x16_bf16 v[112:127], v[132:135], v[140:143], v[112:127]
    buffer_load_dwordx4 v5, s[52:55], s12 offen offset:1024 lds
    ds_read_b64_tr_b16 v[176:177], v36 offset:61440
    s_waitcnt lgkmcnt(10)
    v_mfma_f32_32x32x16_bf16 v[64:79], v[144:147], v[152:155], v[64:79]
    ds_read_b64_tr_b16 v[178:179], v36 offset:62464
    ds_read_b128 v[184:187], v43 offset:32768
    ds_read_b64_tr_b16 v[180:181], v37 offset:61440
    s_waitcnt lgkmcnt(11)
    v_mfma_f32_32x32x16_bf16 v[96:111], v[148:151], v[152:155], v[96:111]
    buffer_load_dwordx4 v6, s[52:55], s12 offen offset:2048 lds
    ds_read_b64_tr_b16 v[182:183], v37 offset:62464
    s_waitcnt lgkmcnt(11)
    v_mfma_f32_32x32x16_bf16 v[80:95], v[144:147], v[156:159], v[80:95]
    ds_read_b128 v[188:191], v43 offset:36864
    v_mfma_f32_32x32x16_bf16 v[112:127], v[148:151], v[156:159], v[112:127]
    buffer_load_dwordx4 v7, s[52:55], s12 offen offset:3072 lds
    s_waitcnt lgkmcnt(9)
    v_mfma_f32_32x32x16_bf16 v[64:79], v[160:163], v[168:171], v[64:79]
    s_waitcnt vmcnt(13)
    s_waitcnt lgkmcnt(0)
    s_barrier
    v_mfma_f32_32x32x16_bf16 v[96:111], v[164:167], v[168:171], v[96:111]
    s_add_u32 m0, s15, 32768
    s_add_u32 s13, s13, 229376
    buffer_load_dwordx4 v8, s[56:59], s13 offen offset:0 lds
    ds_read_b64_tr_b16 v[128:129], v38 offset:16384
    v_mfma_f32_32x32x16_bf16 v[80:95], v[160:163], v[172:175], v[80:95]
    ds_read_b64_tr_b16 v[130:131], v38 offset:17408
    ds_read_b128 v[136:139], v44 offset:0
    ds_read_b64_tr_b16 v[132:133], v39 offset:16384
    v_mfma_f32_32x32x16_bf16 v[112:127], v[164:167], v[172:175], v[112:127]
    buffer_load_dwordx4 v9, s[56:59], s13 offen offset:1024 lds
    ds_read_b64_tr_b16 v[134:135], v39 offset:17408
    v_mfma_f32_32x32x16_bf16 v[64:79], v[176:179], v[184:187], v[64:79]
    ds_read_b128 v[140:143], v44 offset:4096
    ds_read_b64_tr_b16 v[144:145], v38 offset:20480
    ds_read_b64_tr_b16 v[146:147], v38 offset:21504
    v_mfma_f32_32x32x16_bf16 v[96:111], v[180:183], v[184:187], v[96:111]
    buffer_load_dwordx4 v10, s[56:59], s13 offen offset:2048 lds
    ds_read_b128 v[152:155], v45 offset:0
    v_mfma_f32_32x32x16_bf16 v[80:95], v[176:179], v[188:191], v[80:95]
    ds_read_b64_tr_b16 v[148:149], v39 offset:20480
    ds_read_b64_tr_b16 v[150:151], v39 offset:21504
    v_mfma_f32_32x32x16_bf16 v[112:127], v[180:183], v[188:191], v[112:127]
    buffer_load_dwordx4 v11, s[56:59], s13 offen offset:3072 lds
    ds_read_b128 v[156:159], v45 offset:4096
    s_waitcnt lgkmcnt(9)
    v_mfma_f32_32x32x16_bf16 v[64:79], v[128:131], v[136:139], v[64:79]
    ds_read_b64_tr_b16 v[160:161], v38 offset:24576
    ds_read_b64_tr_b16 v[162:163], v38 offset:25600
    s_waitcnt lgkmcnt(9)
    v_mfma_f32_32x32x16_bf16 v[96:111], v[132:135], v[136:139], v[96:111]
    s_add_u32 m0, s15, 49152
    s_add_u32 s12, s12, 128
    buffer_load_dwordx4 v4, s[52:55], s12 offen offset:0 lds
    ds_read_b128 v[168:171], v46 offset:0
    s_waitcnt lgkmcnt(9)
    v_mfma_f32_32x32x16_bf16 v[80:95], v[128:131], v[140:143], v[80:95]
    ds_read_b64_tr_b16 v[164:165], v39 offset:24576
    ds_read_b64_tr_b16 v[166:167], v39 offset:25600
    ds_read_b128 v[172:175], v46 offset:4096
    v_mfma_f32_32x32x16_bf16 v[112:127], v[132:135], v[140:143], v[112:127]
    buffer_load_dwordx4 v5, s[52:55], s12 offen offset:1024 lds
    ds_read_b64_tr_b16 v[176:177], v38 offset:28672
    s_waitcnt lgkmcnt(10)
    v_mfma_f32_32x32x16_bf16 v[64:79], v[144:147], v[152:155], v[64:79]
    ds_read_b64_tr_b16 v[178:179], v38 offset:29696
    ds_read_b128 v[184:187], v47 offset:0
    ds_read_b64_tr_b16 v[180:181], v39 offset:28672
    s_waitcnt lgkmcnt(11)
    v_mfma_f32_32x32x16_bf16 v[96:111], v[148:151], v[152:155], v[96:111]
    buffer_load_dwordx4 v6, s[52:55], s12 offen offset:2048 lds
    ds_read_b64_tr_b16 v[182:183], v39 offset:29696
    s_waitcnt lgkmcnt(11)
    v_mfma_f32_32x32x16_bf16 v[80:95], v[144:147], v[156:159], v[80:95]
    ds_read_b128 v[188:191], v47 offset:4096
    v_mfma_f32_32x32x16_bf16 v[112:127], v[148:151], v[156:159], v[112:127]
    buffer_load_dwordx4 v7, s[52:55], s12 offen offset:3072 lds
    s_waitcnt lgkmcnt(9)
    v_mfma_f32_32x32x16_bf16 v[64:79], v[160:163], v[168:171], v[64:79]
    s_waitcnt vmcnt(12)
    s_waitcnt lgkmcnt(0)
    s_barrier
    v_mfma_f32_32x32x16_bf16 v[96:111], v[164:167], v[168:171], v[96:111]
    s_add_u32 m0, s15, 65536
    s_add_u32 s13, s13, 229376
    buffer_load_dwordx4 v8, s[56:59], s13 offen offset:0 lds
    ds_read_b64_tr_b16 v[128:129], v36 offset:0
    v_mfma_f32_32x32x16_bf16 v[80:95], v[160:163], v[172:175], v[80:95]
    ds_read_b64_tr_b16 v[130:131], v36 offset:1024
    ds_read_b128 v[136:139], v44 offset:32768
    ds_read_b64_tr_b16 v[132:133], v37 offset:0
    v_mfma_f32_32x32x16_bf16 v[112:127], v[164:167], v[172:175], v[112:127]
    buffer_load_dwordx4 v9, s[56:59], s13 offen offset:1024 lds
    ds_read_b64_tr_b16 v[134:135], v37 offset:1024
    v_mfma_f32_32x32x16_bf16 v[64:79], v[176:179], v[184:187], v[64:79]
    ds_read_b128 v[140:143], v44 offset:36864
    ds_read_b64_tr_b16 v[144:145], v36 offset:4096
    ds_read_b64_tr_b16 v[146:147], v36 offset:5120
    v_mfma_f32_32x32x16_bf16 v[96:111], v[180:183], v[184:187], v[96:111]
    buffer_load_dwordx4 v10, s[56:59], s13 offen offset:2048 lds
    ds_read_b128 v[152:155], v45 offset:32768
    v_mfma_f32_32x32x16_bf16 v[80:95], v[176:179], v[188:191], v[80:95]
    ds_read_b64_tr_b16 v[148:149], v37 offset:4096
    ds_read_b64_tr_b16 v[150:151], v37 offset:5120
    v_mfma_f32_32x32x16_bf16 v[112:127], v[180:183], v[188:191], v[112:127]
    buffer_load_dwordx4 v11, s[56:59], s13 offen offset:3072 lds
    ds_read_b128 v[156:159], v45 offset:36864
    s_waitcnt lgkmcnt(9)
    v_mfma_f32_32x32x16_bf16 v[64:79], v[128:131], v[136:139], v[64:79]
    ds_read_b64_tr_b16 v[160:161], v36 offset:8192
    ds_read_b64_tr_b16 v[162:163], v36 offset:9216
    s_waitcnt lgkmcnt(9)
    v_mfma_f32_32x32x16_bf16 v[96:111], v[132:135], v[136:139], v[96:111]
    s_add_u32 m0, s15, 81920
    s_add_u32 s12, s12, 128
    buffer_load_dwordx4 v4, s[52:55], s12 offen offset:0 lds
    ds_read_b128 v[168:171], v46 offset:32768
    s_waitcnt lgkmcnt(9)
    v_mfma_f32_32x32x16_bf16 v[80:95], v[128:131], v[140:143], v[80:95]
    ds_read_b64_tr_b16 v[164:165], v37 offset:8192
    ds_read_b64_tr_b16 v[166:167], v37 offset:9216
    ds_read_b128 v[172:175], v46 offset:36864
    v_mfma_f32_32x32x16_bf16 v[112:127], v[132:135], v[140:143], v[112:127]
    buffer_load_dwordx4 v5, s[52:55], s12 offen offset:1024 lds
    ds_read_b64_tr_b16 v[176:177], v36 offset:12288
    s_waitcnt lgkmcnt(10)
    v_mfma_f32_32x32x16_bf16 v[64:79], v[144:147], v[152:155], v[64:79]
    ds_read_b64_tr_b16 v[178:179], v36 offset:13312
    ds_read_b128 v[184:187], v47 offset:32768
    ds_read_b64_tr_b16 v[180:181], v37 offset:12288
    s_waitcnt lgkmcnt(11)
    v_mfma_f32_32x32x16_bf16 v[96:111], v[148:151], v[152:155], v[96:111]
    buffer_load_dwordx4 v6, s[52:55], s12 offen offset:2048 lds
    ds_read_b64_tr_b16 v[182:183], v37 offset:13312
    s_waitcnt lgkmcnt(11)
    v_mfma_f32_32x32x16_bf16 v[80:95], v[144:147], v[156:159], v[80:95]
    ds_read_b128 v[188:191], v47 offset:36864
    v_mfma_f32_32x32x16_bf16 v[112:127], v[148:151], v[156:159], v[112:127]
    buffer_load_dwordx4 v7, s[52:55], s12 offen offset:3072 lds
    s_waitcnt lgkmcnt(9)
    v_mfma_f32_32x32x16_bf16 v[64:79], v[160:163], v[168:171], v[64:79]
    s_waitcnt vmcnt(12)
    s_waitcnt lgkmcnt(0)
    s_barrier
    v_mfma_f32_32x32x16_bf16 v[96:111], v[164:167], v[168:171], v[96:111]
    s_add_u32 m0, s15, 98304
    s_add_u32 s13, s13, 229376
    buffer_load_dwordx4 v8, s[56:59], s13 offen offset:0 lds
    ds_read_b64_tr_b16 v[128:129], v36 offset:32768
    v_mfma_f32_32x32x16_bf16 v[80:95], v[160:163], v[172:175], v[80:95]
    ds_read_b64_tr_b16 v[130:131], v36 offset:33792
    ds_read_b128 v[136:139], v40 offset:16384
    ds_read_b64_tr_b16 v[132:133], v37 offset:32768
    v_mfma_f32_32x32x16_bf16 v[112:127], v[164:167], v[172:175], v[112:127]
    buffer_load_dwordx4 v9, s[56:59], s13 offen offset:1024 lds
    ds_read_b64_tr_b16 v[134:135], v37 offset:33792
    v_mfma_f32_32x32x16_bf16 v[64:79], v[176:179], v[184:187], v[64:79]
    ds_read_b128 v[140:143], v40 offset:20480
    ds_read_b64_tr_b16 v[144:145], v36 offset:36864
    ds_read_b64_tr_b16 v[146:147], v36 offset:37888
    v_mfma_f32_32x32x16_bf16 v[96:111], v[180:183], v[184:187], v[96:111]
    buffer_load_dwordx4 v10, s[56:59], s13 offen offset:2048 lds
    ds_read_b128 v[152:155], v41 offset:16384
    v_mfma_f32_32x32x16_bf16 v[80:95], v[176:179], v[188:191], v[80:95]
    ds_read_b64_tr_b16 v[148:149], v37 offset:36864
    ds_read_b64_tr_b16 v[150:151], v37 offset:37888
    v_mfma_f32_32x32x16_bf16 v[112:127], v[180:183], v[188:191], v[112:127]
    buffer_load_dwordx4 v11, s[56:59], s13 offen offset:3072 lds
    ds_read_b128 v[156:159], v41 offset:20480
    s_waitcnt lgkmcnt(9)
    v_mfma_f32_32x32x16_bf16 v[64:79], v[128:131], v[136:139], v[64:79]
    ds_read_b64_tr_b16 v[160:161], v36 offset:40960
    ds_read_b64_tr_b16 v[162:163], v36 offset:41984
    s_waitcnt lgkmcnt(9)
    v_mfma_f32_32x32x16_bf16 v[96:111], v[132:135], v[136:139], v[96:111]
    s_add_u32 m0, s15, 0
    s_add_u32 s14, s14, 28672
    buffer_load_dwordx4 v12, s[60:63], s14 offen offset:0 lds
    ds_read_b128 v[168:171], v42 offset:16384
    s_waitcnt lgkmcnt(9)
    v_mfma_f32_32x32x16_bf16 v[80:95], v[128:131], v[140:143], v[80:95]
    ds_read_b64_tr_b16 v[164:165], v37 offset:40960
    ds_read_b64_tr_b16 v[166:167], v37 offset:41984
    ds_read_b128 v[172:175], v42 offset:20480
    v_mfma_f32_32x32x16_bf16 v[112:127], v[132:135], v[140:143], v[112:127]
    buffer_load_dwordx4 v13, s[60:63], s14 offen offset:1024 lds
    ds_read_b64_tr_b16 v[176:177], v36 offset:45056
    s_waitcnt lgkmcnt(10)
    v_mfma_f32_32x32x16_bf16 v[64:79], v[144:147], v[152:155], v[64:79]
    ds_read_b64_tr_b16 v[178:179], v36 offset:46080
    ds_read_b128 v[184:187], v43 offset:16384
    ds_read_b64_tr_b16 v[180:181], v37 offset:45056
    s_waitcnt lgkmcnt(11)
    v_mfma_f32_32x32x16_bf16 v[96:111], v[148:151], v[152:155], v[96:111]
    buffer_load_dwordx4 v14, s[60:63], s14 offen offset:2048 lds
    ds_read_b64_tr_b16 v[182:183], v37 offset:46080
    s_waitcnt lgkmcnt(11)
    v_mfma_f32_32x32x16_bf16 v[80:95], v[144:147], v[156:159], v[80:95]
    ds_read_b128 v[188:191], v43 offset:20480
    v_mfma_f32_32x32x16_bf16 v[112:127], v[148:151], v[156:159], v[112:127]
    buffer_load_dwordx4 v15, s[60:63], s14 offen offset:3072 lds
    s_waitcnt lgkmcnt(9)
    v_mfma_f32_32x32x16_bf16 v[64:79], v[160:163], v[168:171], v[64:79]
    s_waitcnt vmcnt(12)
    s_waitcnt lgkmcnt(0)
    s_barrier
    v_mfma_f32_32x32x16_bf16 v[96:111], v[164:167], v[168:171], v[96:111]
    s_add_u32 m0, s15, 16384
    s_add_u32 s14, s14, 28672
    buffer_load_dwordx4 v12, s[60:63], s14 offen offset:0 lds
    ds_read_b64_tr_b16 v[128:129], v38 offset:0
    v_mfma_f32_32x32x16_bf16 v[80:95], v[160:163], v[172:175], v[80:95]
    ds_read_b64_tr_b16 v[130:131], v38 offset:1024
    ds_read_b128 v[136:139], v40 offset:49152
    ds_read_b64_tr_b16 v[132:133], v39 offset:0
    v_mfma_f32_32x32x16_bf16 v[112:127], v[164:167], v[172:175], v[112:127]
    buffer_load_dwordx4 v13, s[60:63], s14 offen offset:1024 lds
    ds_read_b64_tr_b16 v[134:135], v39 offset:1024
    v_mfma_f32_32x32x16_bf16 v[64:79], v[176:179], v[184:187], v[64:79]
    ds_read_b128 v[140:143], v40 offset:53248
    ds_read_b64_tr_b16 v[144:145], v38 offset:4096
    ds_read_b64_tr_b16 v[146:147], v38 offset:5120
    v_mfma_f32_32x32x16_bf16 v[96:111], v[180:183], v[184:187], v[96:111]
    buffer_load_dwordx4 v14, s[60:63], s14 offen offset:2048 lds
    ds_read_b128 v[152:155], v41 offset:49152
    v_mfma_f32_32x32x16_bf16 v[80:95], v[176:179], v[188:191], v[80:95]
    buffer_load_dwordx2 v[30:31], v18, s[64:67], s27 offen offset:256 sc1
    ds_read_b64_tr_b16 v[148:149], v39 offset:4096
    ds_read_b64_tr_b16 v[150:151], v39 offset:5120
    v_mfma_f32_32x32x16_bf16 v[112:127], v[180:183], v[188:191], v[112:127]
    buffer_load_dwordx4 v15, s[60:63], s14 offen offset:3072 lds
    ds_read_b128 v[156:159], v41 offset:53248
    s_waitcnt lgkmcnt(9)
    v_mfma_f32_32x32x16_bf16 v[64:79], v[128:131], v[136:139], v[64:79]
    buffer_load_dwordx2 v[28:29], v18, s[64:67], s27 offen sc1
    ds_read_b64_tr_b16 v[160:161], v38 offset:8192
    ds_read_b64_tr_b16 v[162:163], v38 offset:9216
    s_waitcnt lgkmcnt(9)
    v_mfma_f32_32x32x16_bf16 v[96:111], v[132:135], v[136:139], v[96:111]
    s_add_u32 m0, s15, 32768
    s_add_u32 s14, s14, 28672
    buffer_load_dwordx4 v12, s[60:63], s14 offen offset:0 lds
    ds_read_b128 v[168:171], v42 offset:49152
    s_waitcnt lgkmcnt(9)
    v_mfma_f32_32x32x16_bf16 v[80:95], v[128:131], v[140:143], v[80:95]
    ds_read_b64_tr_b16 v[164:165], v39 offset:8192
    ds_read_b64_tr_b16 v[166:167], v39 offset:9216
    ds_read_b128 v[172:175], v42 offset:53248
    v_mfma_f32_32x32x16_bf16 v[112:127], v[132:135], v[140:143], v[112:127]
    buffer_load_dwordx4 v13, s[60:63], s14 offen offset:1024 lds
    ds_read_b64_tr_b16 v[176:177], v38 offset:12288
    s_waitcnt lgkmcnt(10)
    v_mfma_f32_32x32x16_bf16 v[64:79], v[144:147], v[152:155], v[64:79]
    ds_read_b64_tr_b16 v[178:179], v38 offset:13312
    ds_read_b128 v[184:187], v43 offset:49152
    ds_read_b64_tr_b16 v[180:181], v39 offset:12288
    s_waitcnt lgkmcnt(11)
    v_mfma_f32_32x32x16_bf16 v[96:111], v[148:151], v[152:155], v[96:111]
    buffer_load_dwordx4 v14, s[60:63], s14 offen offset:2048 lds
    ds_read_b64_tr_b16 v[182:183], v39 offset:13312
    s_waitcnt lgkmcnt(11)
    v_mfma_f32_32x32x16_bf16 v[80:95], v[144:147], v[156:159], v[80:95]
    buffer_load_dwordx2 v[26:27], v17, s[64:67], s26 offen sc1
    ds_read_b128 v[188:191], v43 offset:53248
    v_mfma_f32_32x32x16_bf16 v[112:127], v[148:151], v[156:159], v[112:127]
    buffer_load_dwordx4 v15, s[60:63], s14 offen offset:3072 lds
    s_waitcnt lgkmcnt(9)
    v_mfma_f32_32x32x16_bf16 v[64:79], v[160:163], v[168:171], v[64:79]
    s_waitcnt vmcnt(15)
    s_waitcnt lgkmcnt(0)
    s_barrier
    v_mfma_f32_32x32x16_bf16 v[96:111], v[164:167], v[168:171], v[96:111]
    s_add_u32 m0, s15, 49152
    s_add_u32 s14, s14, 28672
    buffer_load_dwordx4 v12, s[60:63], s14 offen offset:0 lds
    ds_read_b64_tr_b16 v[128:129], v38 offset:32768
    ds_read_b64_tr_b16 v[130:131], v38 offset:33792
    v_mfma_f32_32x32x16_bf16 v[80:95], v[160:163], v[172:175], v[80:95]
    buffer_load_dwordx4 v13, s[60:63], s14 offen offset:1024 lds
    ds_read_b128 v[136:139], v44 offset:16384
    ds_read_b64_tr_b16 v[144:145], v38 offset:36864
    v_mfma_f32_32x32x16_bf16 v[112:127], v[164:167], v[172:175], v[112:127]
    buffer_load_dwordx4 v14, s[60:63], s14 offen offset:2048 lds
    ds_read_b64_tr_b16 v[146:147], v38 offset:37888
    ds_read_b128 v[152:155], v45 offset:16384
    v_mfma_f32_32x32x16_bf16 v[64:79], v[176:179], v[184:187], v[64:79]
    buffer_load_dwordx4 v15, s[60:63], s14 offen offset:3072 lds
    ds_read_b64_tr_b16 v[192:193], v38 offset:40960
    ds_read_b64_tr_b16 v[194:195], v38 offset:41984
    v_mfma_f32_32x32x16_bf16 v[96:111], v[180:183], v[184:187], v[96:111]
    s_add_u32 m0, s15, 65536
    s_add_u32 s14, s14, 28672
    buffer_load_dwordx4 v12, s[60:63], s14 offen offset:0 lds
    ds_read_b128 v[200:203], v46 offset:16384
    ds_read_b64_tr_b16 v[208:209], v38 offset:45056
    v_mfma_f32_32x32x16_bf16 v[80:95], v[176:179], v[188:191], v[80:95]
    buffer_load_dwordx4 v13, s[60:63], s14 offen offset:1024 lds
    ds_read_b64_tr_b16 v[210:211], v38 offset:46080
    v_mfma_f32_32x32x16_bf16 v[112:127], v[180:183], v[188:191], v[112:127]
    buffer_load_dwordx4 v14, s[60:63], s14 offen offset:2048 lds
    ds_read_b128 v[216:219], v47 offset:16384
    s_waitcnt lgkmcnt(9)
    v_mfma_f32_32x32x16_bf16 v[64:79], v[128:131], v[136:139], v[64:79]
    buffer_load_dwordx4 v15, s[60:63], s14 offen offset:3072 lds
    ds_read_b64_tr_b16 v[132:133], v39 offset:32768
    ds_read_b64_tr_b16 v[134:135], v39 offset:33792
    ds_read_b64_tr_b16 v[148:149], v39 offset:36864
    s_waitcnt lgkmcnt(9)
    v_mfma_f32_32x32x16_bf16 v[64:79], v[144:147], v[152:155], v[64:79]
    ds_read_b64_tr_b16 v[150:151], v39 offset:37888
    ds_read_b64_tr_b16 v[196:197], v39 offset:40960
    ds_read_b64_tr_b16 v[198:199], v39 offset:41984
    s_waitcnt lgkmcnt(9)
    v_mfma_f32_32x32x16_bf16 v[64:79], v[192:195], v[200:203], v[64:79]
    ds_read_b64_tr_b16 v[212:213], v39 offset:45056
    ds_read_b64_tr_b16 v[214:215], v39 offset:46080
    ds_read_b128 v[140:143], v44 offset:20480
    s_waitcnt lgkmcnt(9)
    v_mfma_f32_32x32x16_bf16 v[64:79], v[208:211], v[216:219], v[64:79]
    ds_read_b128 v[156:159], v45 offset:20480
    ds_read_b128 v[204:207], v46 offset:20480
    ds_read_b128 v[220:223], v47 offset:20480
    s_waitcnt lgkmcnt(10)
    v_mfma_f32_32x32x16_bf16 v[96:111], v[132:135], v[136:139], v[96:111]
    s_waitcnt vmcnt(9)
La_3:
    v_cmp_ne_u32 vcc, s6, v27
    v_cmp_ne_u32 s[8:9], s6, v29
    s_or_b64 vcc, vcc, s[8:9]
    v_cmp_ne_u32 s[8:9], s6, v31
    s_or_b64 vcc, vcc, s[8:9]
    s_cmp_eq_u64 vcc, 0
    s_cbranch_scc0 La_3s
    s_waitcnt lgkmcnt(8)
    v_mfma_f32_32x32x16_bf16 v[96:111], v[148:151], v[152:155], v[96:111]
    s_waitcnt lgkmcnt(0)
    s_barrier
    v_mov_b32 v24, v26
    s_mov_b32 s8, 0x01000100
    v_cmp_eq_u32 vcc, 0, v20
    v_lshrrev_b32 v29, 16, v28
    v_perm_b32 v28, v28, v28, s8
    v_mfma_f32_32x32x16_bf16 v[96:111], v[196:199], v[200:203], v[96:111]
    v_lshrrev_b32 v31, 16, v30
    v_perm_b32 v30, v30, v30, s8
    v_cndmask_b32 v52, 0, v28, vcc
    v_sub_u32 v56, v28, v52
    v_cndmask_b32 v53, 0, v29, vcc
    v_sub_u32 v57, v29, v53
    v_cndmask_b32 v54, 0, v30, vcc
    v_sub_u32 v58, v30, v54
    v_cndmask_b32 v55, 0, v31, vcc
    v_sub_u32 v59, v31, v55
    buffer_load_dword v32, v19, s[64:67], s21 offen sc1
    v_mfma_f32_32x32x8_bf16 v[64:79], v[24:25], v[52:53], v[64:79]
    v_mfma_f32_32x32x16_bf16 v[96:111], v[212:215], v[216:219], v[96:111]
    v_mfma_f32_32x32x8_bf16 v[96:111], v[24:25], v[56:57], v[96:111]
    s_nop 9
    v_mul_f32 v64, v64, abs(v64)
    v_mul_f32 v65, v65, abs(v65)
    v_mul_f32 v66, v66, abs(v66)
    v_mul_f32 v67, v67, abs(v67)
    v_mul_f32 v68, v68, abs(v68)
    v_mfma_f32_32x32x16_bf16 v[80:95], v[128:131], v[140:143], v[80:95]
    v_mul_f32 v69, v69, abs(v69)
    v_mul_f32 v70, v70, abs(v70)
    v_mul_f32 v71, v71, abs(v71)
    v_cvt_pk_bf16_f32 v64, v64, v65
    v_cvt_pk_bf16_f32 v65, v66, v67
    v_mfma_f32_32x32x16_bf16 v[80:95], v[144:147], v[156:159], v[80:95]
    v_cvt_pk_bf16_f32 v66, v68, v69
    v_cvt_pk_bf16_f32 v67, v70, v71
    v_pk_max_i16 v64, v64, 0
    v_pk_max_i16 v65, v65, 0
    v_pk_max_i16 v66, v66, 0
    v_mfma_f32_32x32x16_bf16 v[80:95], v[192:195], v[204:207], v[80:95]
    v_pk_max_i16 v67, v67, 0
    buffer_store_dwordx4 v[64:67], v16, s[64:67], s22 offen offset:0 sc1
    v_mfma_f32_32x32x16_bf16 v[80:95], v[208:211], v[220:223], v[80:95]
    v_mul_f32 v72, v72, abs(v72)
    v_mul_f32 v73, v73, abs(v73)
    v_mul_f32 v74, v74, abs(v74)
    v_mul_f32 v75, v75, abs(v75)
    v_mul_f32 v76, v76, abs(v76)
    v_mfma_f32_32x32x8_bf16 v[80:95], v[24:25], v[54:55], v[80:95]
    v_mul_f32 v77, v77, abs(v77)
    v_mul_f32 v78, v78, abs(v78)
    v_mul_f32 v79, v79, abs(v79)
    v_cvt_pk_bf16_f32 v72, v72, v73
    v_cvt_pk_bf16_f32 v73, v74, v75
    v_mfma_f32_32x32x16_bf16 v[112:127], v[132:135], v[140:143], v[112:127]
    v_cvt_pk_bf16_f32 v74, v76, v77
    v_cvt_pk_bf16_f32 v75, v78, v79
    v_pk_max_i16 v72, v72, 0
    v_pk_max_i16 v73, v73, 0
    v_pk_max_i16 v74, v74, 0
    v_mfma_f32_32x32x16_bf16 v[112:127], v[148:151], v[156:159], v[112:127]
    v_pk_max_i16 v75, v75, 0
    buffer_store_dwordx4 v[72:75], v16, s[64:67], s22 offen offset:1024 sc1
    v_mfma_f32_32x32x16_bf16 v[112:127], v[196:199], v[204:207], v[112:127]
    v_mul_f32 v96, v96, abs(v96)
    v_mul_f32 v97, v97, abs(v97)
    v_mul_f32 v98, v98, abs(v98)
    v_mul_f32 v99, v99, abs(v99)
    v_mul_f32 v100, v100, abs(v100)
    v_mfma_f32_32x32x16_bf16 v[112:127], v[212:215], v[220:223], v[112:127]
    v_mul_f32 v101, v101, abs(v101)
    v_mul_f32 v102, v102, abs(v102)
    v_mul_f32 v103, v103, abs(v103)
    v_cvt_pk_bf16_f32 v96, v96, v97
    v_cvt_pk_bf16_f32 v97, v98, v99
    v_mfma_f32_32x32x8_bf16 v[112:127], v[24:25], v[58:59], v[112:127]
    v_cvt_pk_bf16_f32 v98, v100, v101
    v_cvt_pk_bf16_f32 v99, v102, v103
    v_pk_max_i16 v96, v96, 0
    v_pk_max_i16 v97, v97, 0
    v_pk_max_i16 v98, v98, 0
    v_pk_max_i16 v99, v99, 0
    buffer_store_dwordx4 v[96:99], v16, s[64:67], s22 offen offset:2048 sc1
    v_mul_f32 v104, v104, abs(v104)
    v_mul_f32 v105, v105, abs(v105)
    v_mul_f32 v106, v106, abs(v106)
    v_mul_f32 v107, v107, abs(v107)
    v_mul_f32 v108, v108, abs(v108)
    v_mul_f32 v109, v109, abs(v109)
    v_mul_f32 v110, v110, abs(v110)
    v_mul_f32 v111, v111, abs(v111)
    v_cvt_pk_bf16_f32 v104, v104, v105
    v_cvt_pk_bf16_f32 v105, v106, v107
    v_cvt_pk_bf16_f32 v106, v108, v109
    v_cvt_pk_bf16_f32 v107, v110, v111
    v_pk_max_i16 v104, v104, 0
    v_pk_max_i16 v105, v105, 0
    v_pk_max_i16 v106, v106, 0
    v_pk_max_i16 v107, v107, 0
    buffer_store_dwordx4 v[104:107], v16, s[64:67], s22 offen offset:3072 sc1
    v_mul_f32 v80, v80, abs(v80)
    v_mul_f32 v81, v81, abs(v81)
    v_mul_f32 v82, v82, abs(v82)
    v_mul_f32 v83, v83, abs(v83)
    v_mul_f32 v84, v84, abs(v84)
    v_mul_f32 v85, v85, abs(v85)
    v_mul_f32 v86, v86, abs(v86)
    v_mul_f32 v87, v87, abs(v87)
    v_cvt_pk_bf16_f32 v80, v80, v81
    v_cvt_pk_bf16_f32 v81, v82, v83
    v_cvt_pk_bf16_f32 v82, v84, v85
    v_cvt_pk_bf16_f32 v83, v86, v87
    v_pk_max_i16 v80, v80, 0
    v_pk_max_i16 v81, v81, 0
    v_pk_max_i16 v82, v82, 0
    v_pk_max_i16 v83, v83, 0
    buffer_store_dwordx4 v[80:83], v16, s[64:67], s23 offen offset:0 sc1
    v_mul_f32 v88, v88, abs(v88)
    v_mul_f32 v89, v89, abs(v89)
    v_mul_f32 v90, v90, abs(v90)
    v_mul_f32 v91, v91, abs(v91)
    v_mul_f32 v92, v92, abs(v92)
    v_mul_f32 v93, v93, abs(v93)
    v_mul_f32 v94, v94, abs(v94)
    v_mul_f32 v95, v95, abs(v95)
    v_cvt_pk_bf16_f32 v88, v88, v89
    v_cvt_pk_bf16_f32 v89, v90, v91
    v_cvt_pk_bf16_f32 v90, v92, v93
    v_cvt_pk_bf16_f32 v91, v94, v95
    v_pk_max_i16 v88, v88, 0
    v_pk_max_i16 v89, v89, 0
    v_pk_max_i16 v90, v90, 0
    v_pk_max_i16 v91, v91, 0
    buffer_store_dwordx4 v[88:91], v16, s[64:67], s23 offen offset:1024 sc1
    v_mul_f32 v112, v112, abs(v112)
    v_mul_f32 v113, v113, abs(v113)
    v_mul_f32 v114, v114, abs(v114)
    v_mul_f32 v115, v115, abs(v115)
    v_mul_f32 v116, v116, abs(v116)
    v_mul_f32 v117, v117, abs(v117)
    v_mul_f32 v118, v118, abs(v118)
    v_mul_f32 v119, v119, abs(v119)
    v_cvt_pk_bf16_f32 v112, v112, v113
    v_cvt_pk_bf16_f32 v113, v114, v115
    v_cvt_pk_bf16_f32 v114, v116, v117
    v_cvt_pk_bf16_f32 v115, v118, v119
    v_pk_max_i16 v112, v112, 0
    v_pk_max_i16 v113, v113, 0
    v_pk_max_i16 v114, v114, 0
    v_pk_max_i16 v115, v115, 0
    buffer_store_dwordx4 v[112:115], v16, s[64:67], s23 offen offset:2048 sc1
    v_mul_f32 v120, v120, abs(v120)
    v_mul_f32 v121, v121, abs(v121)
    v_mul_f32 v122, v122, abs(v122)
    v_mul_f32 v123, v123, abs(v123)
    v_mul_f32 v124, v124, abs(v124)
    v_mul_f32 v125, v125, abs(v125)
    v_mul_f32 v126, v126, abs(v126)
    v_mul_f32 v127, v127, abs(v127)
    v_cvt_pk_bf16_f32 v120, v120, v121
    v_cvt_pk_bf16_f32 v121, v122, v123
    v_cvt_pk_bf16_f32 v122, v124, v125
    v_cvt_pk_bf16_f32 v123, v126, v127
    v_pk_max_i16 v120, v120, 0
    v_pk_max_i16 v121, v121, 0
    v_pk_max_i16 v122, v122, 0
    v_pk_max_i16 v123, v123, 0
    buffer_store_dwordx4 v[120:123], v16, s[64:67], s23 offen offset:3072 sc1
    s_setprio 0
    s_cmp_eq_u32 s4, 7
    s_cselect_b32 s20, 3, s4
    s_mov_b32 s18, s46
    s_add_u32 s19, s18, 802816
    s_mul_i32 s8, s20, 114688
    s_add_u32 s46, s46, s8
    s_waitcnt vmcnt(8)
La_4:
    v_cmp_ne_u32 vcc, s6, v32
    s_cmp_eq_u64 vcc, 0
    s_cbranch_scc0 La_4s
    buffer_load_dwordx4 v[224:227], v33, s[64:67], s46 offen offset:0 sc1
    buffer_load_dwordx4 v[228:231], v34, s[64:67], s46 offen offset:0 sc1
    s_add_u32 s46, s46, 57344
    buffer_load_dwordx4 v[232:235], v33, s[64:67], s46 offen offset:0 sc1
    buffer_load_dwordx4 v[236:239], v34, s[64:67], s46 offen offset:0 sc1
    s_add_u32 s46, s46, 57344
    s_cmp_eq_u32 s46, s19
    s_cselect_b32 s46, s18, s46
    buffer_load_dwordx4 v[240:243], v33, s[64:67], s46 offen offset:0 sc1
    buffer_load_dwordx4 v[244:247], v34, s[64:67], s46 offen offset:0 sc1
    s_add_u32 s46, s46, 57344
    buffer_load_dwordx4 v[248:251], v33, s[64:67], s46 offen offset:0 sc1
    buffer_load_dwordx4 v[252:255], v34, s[64:67], s46 offen offset:0 sc1
    s_mul_i32 s8, s7, 896
    v_min_u32 v19, 6, v0
    v_lshl_add_u32 v19, v19, 7, s8
    s_lshr_b32 s13, s50, 1
    s_lshl_b32 s13, s13, 12
    s_add_u32 s13, s13, 524288
    s_mul_i32 s101, s50, 115456
    s_mul_i32 s8, s7, 28672
    s_add_u32 s101, s101, s8
    s_add_u32 s101, s101, 6291456
    s_lshr_b32 s8, s7, 1
    s_mul_i32 s8, s8, 115456
    s_sub_u32 s9, 115456, s8
    v_add_u32 v17, s8, v16
    v_add_u32 v18, s9, v16
    s_lshl_b32 s25, s25, 12
    s_lshl_b32 s9, s24, 7
    s_add_u32 s25, s25, s9
    s_add_u32 s25, s25, 524288
    s_mov_b32 s68, s44
    s_and_b32 s69, s45, 0xffff
    s_mov_b32 s70, 1835008
    s_mov_b32 s71, 0x20000
    v_lshrrev_b32 v22, 5, v0
    v_lshlrev_b32 v22, 30, v22
    v_lshl_add_u32 v22, v0, 2, v22
    s_waitcnt vmcnt(8)
    buffer_store_dword v23, v22, s[64:67], s25 offen sc1
    s_lshl_b32 s8, s7, 2
    v_add_u32 v22, s8, v1
    s_add_u32 s46, s46, 57344
    s_cmp_eq_u32 s46, s19
    s_cselect_b32 s46, s18, s46
    buffer_load_dwordx4 v[144:147], v33, s[64:67], s46 offen offset:0 sc1
    buffer_load_dwordx4 v[148:151], v34, s[64:67], s46 offen offset:0 sc1
    s_add_u32 s46, s46, 57344
    buffer_load_dwordx4 v[152:155], v33, s[64:67], s46 offen offset:0 sc1
    buffer_load_dwordx4 v[156:159], v34, s[64:67], s46 offen offset:0 sc1
    s_add_u32 s46, s46, 57344
    s_cmp_eq_u32 s46, s19
    s_cselect_b32 s46, s18, s46
    buffer_load_dwordx4 v[160:163], v33, s[64:67], s46 offen offset:0 sc1
    buffer_load_dwordx4 v[164:167], v34, s[64:67], s46 offen offset:0 sc1
    s_add_u32 s46, s46, 57344
    buffer_load_dwordx4 v[168:171], v33, s[64:67], s46 offen offset:0 sc1
    buffer_load_dwordx4 v[172:175], v34, s[64:67], s46 offen offset:0 sc1
    s_add_u32 s46, s46, 57344
    s_cmp_eq_u32 s46, s19
    s_cselect_b32 s46, s18, s46
    buffer_load_dwordx4 v[176:179], v33, s[64:67], s46 offen offset:0 sc1
    buffer_load_dwordx4 v[180:183], v34, s[64:67], s46 offen offset:0 sc1
    s_add_u32 s46, s46, 57344
    buffer_load_dwordx4 v[184:187], v33, s[64:67], s46 offen offset:0 sc1
    buffer_load_dwordx4 v[188:191], v34, s[64:67], s46 offen offset:0 sc1
    s_add_u32 s46, s46, 57344
    s_cmp_eq_u32 s46, s19
    s_cselect_b32 s46, s18, s46
    buffer_load_dwordx4 v[192:195], v33, s[64:67], s46 offen offset:0 sc1
    buffer_load_dwordx4 v[196:199], v34, s[64:67], s46 offen offset:0 sc1
    s_add_u32 s46, s46, 57344
    buffer_load_dwordx4 v[200:203], v33, s[64:67], s46 offen offset:0 sc1
    buffer_load_dwordx4 v[204:207], v34, s[64:67], s46 offen offset:0 sc1
    s_add_u32 s46, s46, 57344
    s_cmp_eq_u32 s46, s19
    s_cselect_b32 s46, s18, s46
    buffer_load_dwordx4 v[208:211], v33, s[64:67], s46 offen offset:0 sc1
    buffer_load_dwordx4 v[212:215], v34, s[64:67], s46 offen offset:0 sc1
    s_add_u32 s46, s46, 57344
    buffer_load_dwordx4 v[216:219], v33, s[64:67], s46 offen offset:0 sc1
    buffer_load_dwordx4 v[220:223], v34, s[64:67], s46 offen offset:0 sc1
    s_add_u32 m0, s15, 81920
    s_add_u32 s14, s14, 28672
    buffer_load_dwordx4 v12, s[60:63], s14 offen offset:0 lds
    buffer_load_dwordx4 v13, s[60:63], s14 offen offset:1024 lds
    buffer_load_dwordx4 v14, s[60:63], s14 offen offset:2048 lds
    buffer_load_dwordx4 v15, s[60:63], s14 offen offset:3072 lds
    buffer_load_dword v24, v19, s[64:67], s13 offen sc1
    s_add_u32 m0, s15, 98304
    s_add_u32 s14, s14, 28672
    buffer_load_dwordx4 v12, s[60:63], s14 offen offset:0 lds
    buffer_load_dwordx4 v13, s[60:63], s14 offen offset:1024 lds
    buffer_load_dwordx4 v14, s[60:63], s14 offen offset:2048 lds
    buffer_load_dwordx4 v15, s[60:63], s14 offen offset:3072 lds
    s_waitcnt vmcnt(4)
La_5:
    v_cmp_ne_u32 vcc, s6, v24
    s_cmp_eq_u64 vcc, 0
    s_cbranch_scc0 La_5s
    s_lshl_b32 s47, s20, 11
    s_add_u32 s47, s47, s101
    s_add_u32 s26, s101, 14336
    buffer_load_dwordx4 v[24:27], v17, s[64:67], s47 offen offset:0 sc1
    buffer_load_dwordx4 v[28:31], v18, s[64:67], s47 offen offset:0 sc1
    buffer_load_dwordx4 v[36:39], v17, s[64:67], s47 offen offset:1024 sc1
    buffer_load_dwordx4 v[40:43], v18, s[64:67], s47 offen offset:1024 sc1
    s_add_u32 s47, s47, 2048
    s_cmp_eq_u32 s47, s26
    s_cselect_b32 s47, s101, s47
    buffer_load_dwordx4 v[44:47], v17, s[64:67], s47 offen offset:0 sc1
    buffer_load_dwordx4 v[52:55], v18, s[64:67], s47 offen offset:0 sc1
    buffer_load_dwordx4 v[56:59], v17, s[64:67], s47 offen offset:1024 sc1
    buffer_load_dwordx4 v[60:63], v18, s[64:67], s47 offen offset:1024 sc1
    s_waitcnt vmcnt(7)
    v_mfma_f32_32x32x16_bf16 v[64:79], v[224:227], v[24:27], 0
    v_mfma_f32_32x32x16_bf16 v[80:95], v[228:231], v[24:27], 0
    s_add_u32 s47, s47, 2048
    s_cmp_eq_u32 s47, s26
    s_cselect_b32 s47, s101, s47
    buffer_load_dwordx4 v[8:11], v17, s[64:67], s47 offen offset:0 sc1
    buffer_load_dwordx4 v[128:131], v18, s[64:67], s47 offen offset:0 sc1
    s_waitcnt vmcnt(8)
    v_mfma_f32_32x32x16_bf16 v[96:111], v[224:227], v[28:31], 0
    v_mfma_f32_32x32x16_bf16 v[112:127], v[228:231], v[28:31], 0
    buffer_load_dwordx4 v[132:135], v17, s[64:67], s47 offen offset:1024 sc1
    buffer_load_dwordx4 v[136:139], v18, s[64:67], s47 offen offset:1024 sc1
    s_waitcnt vmcnt(9)
    v_mfma_f32_32x32x16_bf16 v[64:79], v[232:235], v[36:39], v[64:79]
    v_mfma_f32_32x32x16_bf16 v[80:95], v[236:239], v[36:39], v[80:95]
    s_add_u32 s47, s47, 2048
    s_cmp_eq_u32 s47, s26
    s_cselect_b32 s47, s101, s47
    buffer_load_dwordx4 v[140:143], v17, s[64:67], s47 offen offset:0 sc1
    buffer_load_dwordx4 v[24:27], v18, s[64:67], s47 offen offset:0 sc1
    s_waitcnt vmcnt(10)
    v_mfma_f32_32x32x16_bf16 v[96:111], v[232:235], v[40:43], v[96:111]
    v_mfma_f32_32x32x16_bf16 v[112:127], v[236:239], v[40:43], v[112:127]
    buffer_load_dwordx4 v[28:31], v17, s[64:67], s47 offen offset:1024 sc1
    buffer_load_dwordx4 v[36:39], v18, s[64:67], s47 offen offset:1024 sc1
    s_waitcnt vmcnt(11)
    v_mfma_f32_32x32x16_bf16 v[64:79], v[240:243], v[44:47], v[64:79]
    v_mfma_f32_32x32x16_bf16 v[80:95], v[244:247], v[44:47], v[80:95]
    s_add_u32 s47, s47, 2048
    s_cmp_eq_u32 s47, s26
    s_cselect_b32 s47, s101, s47
    buffer_load_dwordx4 v[40:43], v17, s[64:67], s47 offen offset:0 sc1
    buffer_load_dwordx4 v[224:227], v18, s[64:67], s47 offen offset:0 sc1
    s_waitcnt vmcnt(12)
    v_mfma_f32_32x32x16_bf16 v[96:111], v[240:243], v[52:55], v[96:111]
    v_mfma_f32_32x32x16_bf16 v[112:127], v[244:247], v[52:55], v[112:127]
    buffer_load_dwordx4 v[228:231], v17, s[64:67], s47 offen offset:1024 sc1
    buffer_load_dwordx4 v[232:235], v18, s[64:67], s47 offen offset:1024 sc1
    s_waitcnt vmcnt(13)
    v_mfma_f32_32x32x16_bf16 v[64:79], v[248:251], v[56:59], v[64:79]
    v_mfma_f32_32x32x16_bf16 v[80:95], v[252:255], v[56:59], v[80:95]
    s_add_u32 s47, s47, 2048
    s_cmp_eq_u32 s47, s26
    s_cselect_b32 s47, s101, s47
    buffer_load_dwordx4 v[236:239], v17, s[64:67], s47 offen offset:0 sc1
    s_waitcnt vmcnt(13)
    v_mfma_f32_32x32x16_bf16 v[96:111], v[248:251], v[60:63], v[96:111]
    v_mfma_f32_32x32x16_bf16 v[112:127], v[252:255], v[60:63], v[112:127]
    buffer_load_dwordx4 v[44:47], v18, s[64:67], s47 offen offset:0 sc1
    s_waitcnt vmcnt(13)
    v_mfma_f32_32x32x16_bf16 v[64:79], v[144:147], v[8:11], v[64:79]
    v_mfma_f32_32x32x16_bf16 v[80:95], v[148:151], v[8:11], v[80:95]
    buffer_load_dwordx4 v[52:55], v17, s[64:67], s47 offen offset:1024 sc1
    s_waitcnt vmcnt(13)
    v_mfma_f32_32x32x16_bf16 v[96:111], v[144:147], v[128:131], v[96:111]
    v_mfma_f32_32x32x16_bf16 v[112:127], v[148:151], v[128:131], v[112:127]
    buffer_load_dwordx4 v[56:59], v18, s[64:67], s47 offen offset:1024 sc1
    s_waitcnt vmcnt(13)
    v_mfma_f32_32x32x16_bf16 v[64:79], v[152:155], v[132:135], v[64:79]
    v_mfma_f32_32x32x16_bf16 v[80:95], v[156:159], v[132:135], v[80:95]
    s_add_u32 s47, s47, 2048
    s_cmp_eq_u32 s47, s26
    s_cselect_b32 s47, s101, s47
    buffer_load_dwordx4 v[60:63], v17, s[64:67], s47 offen offset:0 sc1
    s_waitcnt vmcnt(13)
    v_mfma_f32_32x32x16_bf16 v[96:111], v[152:155], v[136:139], v[96:111]
    v_mfma_f32_32x32x16_bf16 v[112:127], v[156:159], v[136:139], v[112:127]
    buffer_load_dwordx4 v[240:243], v18, s[64:67], s47 offen offset:0 sc1
    s_waitcnt vmcnt(13)
    v_mfma_f32_32x32x16_bf16 v[64:79], v[160:163], v[140:143], v[64:79]
    v_mfma_f32_32x32x16_bf16 v[80:95], v[164:167], v[140:143], v[80:95]
    buffer_load_dwordx4 v[244:247], v17, s[64:67], s47 offen offset:1024 sc1
    s_waitcnt vmcnt(13)
    v_mfma_f32_32x32x16_bf16 v[96:111], v[160:163], v[24:27], v[96:111]
    v_mfma_f32_32x32x16_bf16 v[112:127], v[164:167], v[24:27], v[112:127]
    buffer_load_dwordx4 v[248:251], v18, s[64:67], s47 offen offset:1024 sc1
    s_waitcnt vmcnt(13)
    v_mfma_f32_32x32x16_bf16 v[64:79], v[168:171], v[28:31], v[64:79]
    v_mfma_f32_32x32x16_bf16 v[80:95], v[172:175], v[28:31], v[80:95]
    s_add_u32 s47, s101, 12288
    buffer_load_dwordx4 v[252:255], v17, s[64:67], s47 offen offset:2048 sc1
    s_waitcnt vmcnt(13)
    v_mfma_f32_32x32x16_bf16 v[96:111], v[168:171], v[36:39], v[96:111]
    v_mfma_f32_32x32x16_bf16 v[112:127], v[172:175], v[36:39], v[112:127]
    buffer_load_dwordx4 v[8:11], v18, s[64:67], s47 offen offset:2048 sc1
    s_waitcnt vmcnt(13)
    v_mfma_f32_32x32x16_bf16 v[64:79], v[176:179], v[40:43], v[64:79]
    v_mfma_f32_32x32x16_bf16 v[80:95], v[180:183], v[40:43], v[80:95]
    buffer_load_dwordx4 v[128:131], v17, s[64:67], s47 offen offset:3072 sc1
    s_waitcnt vmcnt(13)
    v_mfma_f32_32x32x16_bf16 v[96:111], v[176:179], v[224:227], v[96:111]
    v_mfma_f32_32x32x16_bf16 v[112:127], v[180:183], v[224:227], v[112:127]
    buffer_load_dwordx4 v[132:135], v18, s[64:67], s47 offen offset:3072 sc1
    s_waitcnt vmcnt(13)
    v_mfma_f32_32x32x16_bf16 v[64:79], v[184:187], v[228:231], v[64:79]
    v_mfma_f32_32x32x16_bf16 v[80:95], v[188:191], v[228:231], v[80:95]
    s_add_u32 s47, s101, 16384
    buffer_load_dwordx4 v[136:139], v17, s[64:67], s47 offen offset:0 sc1
    s_waitcnt vmcnt(13)
    v_mfma_f32_32x32x16_bf16 v[96:111], v[184:187], v[232:235], v[96:111]
    v_mfma_f32_32x32x16_bf16 v[112:127], v[188:191], v[232:235], v[112:127]
    buffer_load_dwordx4 v[144:147], v18, s[64:67], s47 offen offset:0 sc1
    s_waitcnt vmcnt(13)
    v_mfma_f32_32x32x16_bf16 v[64:79], v[192:195], v[236:239], v[64:79]
    ds_read_b64_tr_b16 v[176:177], v48 offset:0
    ds_read_b64_tr_b16 v[178:179], v48 offset:1024
    v_mfma_f32_32x32x16_bf16 v[80:95], v[196:199], v[236:239], v[80:95]
    buffer_load_dwordx4 v[148:151], v17, s[64:67], s47 offen offset:1024 sc1
    s_waitcnt vmcnt(13)
    v_mfma_f32_32x32x16_bf16 v[96:111], v[192:195], v[44:47], v[96:111]
    ds_read_b64_tr_b16 v[180:181], v49 offset:0
    ds_read_b64_tr_b16 v[182:183], v49 offset:1024
    v_mfma_f32_32x32x16_bf16 v[112:127], v[196:199], v[44:47], v[112:127]
    buffer_load_dwordx4 v[152:155], v18, s[64:67], s47 offen offset:1024 sc1
    s_waitcnt vmcnt(13)
    v_mfma_f32_32x32x16_bf16 v[64:79], v[200:203], v[52:55], v[64:79]
    ds_read_b64_tr_b16 v[184:185], v48 offset:2048
    ds_read_b64_tr_b16 v[186:187], v48 offset:3072
    v_mfma_f32_32x32x16_bf16 v[80:95], v[204:207], v[52:55], v[80:95]
    buffer_load_dwordx4 v[156:159], v17, s[64:67], s47 offen offset:2048 sc1
    s_waitcnt vmcnt(13)
    v_mfma_f32_32x32x16_bf16 v[96:111], v[200:203], v[56:59], v[96:111]
    ds_read_b64_tr_b16 v[188:189], v49 offset:2048
    ds_read_b64_tr_b16 v[190:191], v49 offset:3072
    v_mfma_f32_32x32x16_bf16 v[112:127], v[204:207], v[56:59], v[112:127]
    buffer_load_dwordx4 v[140:143], v18, s[64:67], s47 offen offset:2048 sc1
    s_waitcnt vmcnt(13)
    v_mfma_f32_32x32x16_bf16 v[64:79], v[208:211], v[60:63], v[64:79]
    ds_read_b64_tr_b16 v[192:193], v48 offset:16384
    ds_read_b64_tr_b16 v[194:195], v48 offset:17408
    v_mfma_f32_32x32x16_bf16 v[80:95], v[212:215], v[60:63], v[80:95]
    buffer_load_dwordx4 v[24:27], v17, s[64:67], s47 offen offset:3072 sc1
    s_waitcnt vmcnt(13)
    v_mfma_f32_32x32x16_bf16 v[96:111], v[208:211], v[240:243], v[96:111]
    ds_read_b64_tr_b16 v[196:197], v49 offset:16384
    ds_read_b64_tr_b16 v[198:199], v49 offset:17408
    v_mfma_f32_32x32x16_bf16 v[112:127], v[212:215], v[240:243], v[112:127]
    buffer_load_dwordx4 v[28:31], v18, s[64:67], s47 offen offset:3072 sc1
    s_waitcnt vmcnt(13)
    v_mfma_f32_32x32x16_bf16 v[64:79], v[216:219], v[244:247], v[64:79]
    ds_read_b64_tr_b16 v[200:201], v48 offset:18432
    ds_read_b64_tr_b16 v[202:203], v48 offset:19456
    v_mfma_f32_32x32x16_bf16 v[80:95], v[220:223], v[244:247], v[80:95]
    s_add_u32 s47, s101, 20480
    buffer_load_dwordx4 v[36:39], v17, s[64:67], s47 offen offset:0 sc1
    s_waitcnt vmcnt(13)
    v_mfma_f32_32x32x16_bf16 v[96:111], v[216:219], v[248:251], v[96:111]
    ds_read_b64_tr_b16 v[204:205], v49 offset:18432
    ds_read_b64_tr_b16 v[206:207], v49 offset:19456
    v_mfma_f32_32x32x16_bf16 v[112:127], v[220:223], v[248:251], v[112:127]
    buffer_load_dwordx4 v[160:163], v18, s[64:67], s47 offen offset:0 sc1
    s_waitcnt lgkmcnt(8)
    s_waitcnt vmcnt(13)
    v_mfma_f32_32x32x16_bf16 v[64:79], v[176:179], v[252:255], v[64:79]
    ds_read_b64_tr_b16 v[208:209], v48 offset:32768
    ds_read_b64_tr_b16 v[210:211], v48 offset:33792
    v_mfma_f32_32x32x16_bf16 v[80:95], v[180:183], v[252:255], v[80:95]
    buffer_load_dwordx4 v[164:167], v17, s[64:67], s47 offen offset:1024 sc1
    s_waitcnt vmcnt(13)
    v_mfma_f32_32x32x16_bf16 v[96:111], v[176:179], v[8:11], v[96:111]
    ds_read_b64_tr_b16 v[212:213], v49 offset:32768
    ds_read_b64_tr_b16 v[214:215], v49 offset:33792
    v_mfma_f32_32x32x16_bf16 v[112:127], v[180:183], v[8:11], v[112:127]
    buffer_load_dwordx4 v[168:171], v18, s[64:67], s47 offen offset:1024 sc1
    s_waitcnt vmcnt(13)
    v_mfma_f32_32x32x16_bf16 v[64:79], v[184:187], v[128:131], v[64:79]
    ds_read_b64_tr_b16 v[216:217], v48 offset:34816
    ds_read_b64_tr_b16 v[218:219], v48 offset:35840
    v_mfma_f32_32x32x16_bf16 v[80:95], v[188:191], v[128:131], v[80:95]
    buffer_load_dwordx4 v[172:175], v18, s[64:67], s47 offen offset:2048 sc1
    s_waitcnt vmcnt(13)
    v_mfma_f32_32x32x16_bf16 v[96:111], v[184:187], v[132:135], v[96:111]
    ds_read_b64_tr_b16 v[220:221], v49 offset:34816
    ds_read_b64_tr_b16 v[222:223], v49 offset:35840
    v_mfma_f32_32x32x16_bf16 v[112:127], v[188:191], v[132:135], v[112:127]
    buffer_load_dwordx4 v[40:43], v18, s[64:67], s47 offen offset:3072 sc1
    s_waitcnt lgkmcnt(8)
    s_waitcnt vmcnt(13)
    v_mfma_f32_32x32x16_bf16 v[64:79], v[192:195], v[136:139], v[64:79]
    ds_read_b64_tr_b16 v[176:177], v48 offset:49152
    ds_read_b64_tr_b16 v[178:179], v48 offset:50176
    v_mfma_f32_32x32x16_bf16 v[80:95], v[196:199], v[136:139], v[80:95]
    s_add_u32 s47, s101, 24576
    buffer_load_dwordx4 v[224:227], v18, s[64:67], s47 offen offset:0 sc1
    s_waitcnt vmcnt(13)
    v_mfma_f32_32x32x16_bf16 v[96:111], v[192:195], v[144:147], v[96:111]
    ds_read_b64_tr_b16 v[180:181], v49 offset:49152
    ds_read_b64_tr_b16 v[182:183], v49 offset:50176
    v_mfma_f32_32x32x16_bf16 v[112:127], v[196:199], v[144:147], v[112:127]
    buffer_load_dwordx4 v[228:231], v18, s[64:67], s47 offen offset:1024 sc1
    s_waitcnt vmcnt(13)
    v_mfma_f32_32x32x16_bf16 v[64:79], v[200:203], v[148:151], v[64:79]
    ds_read_b64_tr_b16 v[184:185], v48 offset:51200
    ds_read_b64_tr_b16 v[186:187], v48 offset:52224
    v_mfma_f32_32x32x16_bf16 v[80:95], v[204:207], v[148:151], v[80:95]
    buffer_load_dwordx4 v[232:235], v18, s[64:67], s47 offen offset:2048 sc1
    s_waitcnt vmcnt(13)
    v_mfma_f32_32x32x16_bf16 v[96:111], v[200:203], v[152:155], v[96:111]
    ds_read_b64_tr_b16 v[188:189], v49 offset:51200
    ds_read_b64_tr_b16 v[190:191], v49 offset:52224
    v_mfma_f32_32x32x16_bf16 v[112:127], v[204:207], v[152:155], v[112:127]
    buffer_load_dwordx4 v[236:239], v18, s[64:67], s47 offen offset:3072 sc1
    ds_add_u32 v22, v2 offset:104
    s_waitcnt lgkmcnt(9)
    s_waitcnt vmcnt(13)
    v_mfma_f32_32x32x16_bf16 v[64:79], v[208:211], v[156:159], v[64:79]
    ds_read_b64_tr_b16 v[192:193], v50 offset:0
    ds_read_b64_tr_b16 v[194:195], v50 offset:1024
    v_mfma_f32_32x32x16_bf16 v[80:95], v[212:215], v[156:159], v[80:95]
    s_add_u32 s47, s101, 20480
    buffer_load_dwordx4 v[44:47], v17, s[64:67], s47 offen offset:2048 sc1
    s_waitcnt vmcnt(13)
    v_mfma_f32_32x32x16_bf16 v[96:111], v[208:211], v[140:143], v[96:111]
    ds_read_b64_tr_b16 v[196:197], v51 offset:0
    ds_read_b64_tr_b16 v[198:199], v51 offset:1024
    v_mfma_f32_32x32x16_bf16 v[112:127], v[212:215], v[140:143], v[112:127]
    buffer_load_dwordx4 v[52:55], v17, s[64:67], s47 offen offset:3072 sc1
    s_waitcnt vmcnt(13)
    v_mfma_f32_32x32x16_bf16 v[64:79], v[216:219], v[24:27], v[64:79]
    ds_read_b64_tr_b16 v[200:201], v50 offset:2048
    ds_read_b64_tr_b16 v[202:203], v50 offset:3072
    v_mfma_f32_32x32x16_bf16 v[80:95], v[220:223], v[24:27], v[80:95]
    s_add_u32 s47, s101, 24576
    buffer_load_dwordx4 v[56:59], v17, s[64:67], s47 offen offset:0 sc1
    s_waitcnt vmcnt(13)
    v_mfma_f32_32x32x16_bf16 v[96:111], v[216:219], v[28:31], v[96:111]
    ds_read_b64_tr_b16 v[204:205], v51 offset:2048
    ds_read_b64_tr_b16 v[206:207], v51 offset:3072
    v_mfma_f32_32x32x16_bf16 v[112:127], v[220:223], v[28:31], v[112:127]
    buffer_load_dwordx4 v[60:63], v17, s[64:67], s47 offen offset:1024 sc1
    s_waitcnt lgkmcnt(9)
    s_waitcnt vmcnt(13)
    v_mfma_f32_32x32x16_bf16 v[64:79], v[176:179], v[36:39], v[64:79]
    ds_read_b64_tr_b16 v[208:209], v50 offset:16384
    ds_read_b64_tr_b16 v[210:211], v50 offset:17408
    v_mfma_f32_32x32x16_bf16 v[80:95], v[180:183], v[36:39], v[80:95]
    buffer_load_dwordx4 v[240:243], v17, s[64:67], s47 offen offset:2048 sc1
    s_waitcnt vmcnt(13)
    v_mfma_f32_32x32x16_bf16 v[96:111], v[176:179], v[160:163], v[96:111]
    ds_read_b64_tr_b16 v[212:213], v51 offset:16384
    ds_read_b64_tr_b16 v[214:215], v51 offset:17408
    v_mfma_f32_32x32x16_bf16 v[112:127], v[180:183], v[160:163], v[112:127]
    buffer_load_dwordx4 v[244:247], v17, s[64:67], s47 offen offset:3072 sc1
    s_waitcnt vmcnt(13)
    v_mfma_f32_32x32x16_bf16 v[64:79], v[184:187], v[164:167], v[64:79]
    ds_read_b64_tr_b16 v[216:217], v50 offset:18432
    ds_read_b64_tr_b16 v[218:219], v50 offset:19456
    v_mfma_f32_32x32x16_bf16 v[80:95], v[188:191], v[164:167], v[80:95]
    s_waitcnt vmcnt(12)
    v_mfma_f32_32x32x16_bf16 v[96:111], v[184:187], v[168:171], v[96:111]
    ds_read_b64_tr_b16 v[220:221], v51 offset:18432
    ds_read_b64_tr_b16 v[222:223], v51 offset:19456
    v_mfma_f32_32x32x16_bf16 v[112:127], v[188:191], v[168:171], v[112:127]
    ds_read_b64_tr_b16 v[176:177], v50 offset:32768
    ds_read_b64_tr_b16 v[178:179], v50 offset:33792
    ds_read_b64_tr_b16 v[180:181], v51 offset:32768
    ds_read_b64_tr_b16 v[182:183], v51 offset:33792
    ds_read_b64_tr_b16 v[184:185], v50 offset:34816
    ds_read_b64_tr_b16 v[186:187], v50 offset:35840
    ds_read_b64_tr_b16 v[188:189], v51 offset:34816
    ds_read_b64_tr_b16 v[190:191], v51 offset:35840
    s_waitcnt lgkmcnt(15)
    s_waitcnt vmcnt(11)
    v_mfma_f32_32x32x16_bf16 v[112:127], v[196:199], v[172:175], v[112:127]
    v_add_u32 v12, s15, v16
    v_add_u32 v13, 0x10000, v12
    v_xor_b32 v32, 4096, v12
    v_xor_b32 v33, 8192, v12
    s_waitcnt vmcnt(10)
    v_mfma_f32_32x32x16_bf16 v[112:127], v[204:207], v[40:43], v[112:127]
    v_xor_b32 v34, 12288, v12
    s_mul_i32 s8, s7, 8448
    s_add_u32 s8, s8, 118912
    v_add_u32 v14, s8, v16
    s_waitcnt lgkmcnt(8)
    s_waitcnt vmcnt(9)
    v_mfma_f32_32x32x16_bf16 v[112:127], v[212:215], v[224:227], v[112:127]
    s_lshl_b32 s8, s7, 8
    s_add_u32 s8, s8, 159360
    v_lshl_add_u32 v15, v0, 2, s8
    v_mul_u32_u24 v23, 896, v21
    s_waitcnt vmcnt(8)
    v_mfma_f32_32x32x16_bf16 v[112:127], v[220:223], v[228:231], v[112:127]
    v_lshl_add_u32 v23, v20, 4, v23
    s_lshr_b32 s8, s7, 1
    s_add_u32 s10, s50, s8
    s_mul_i32 s10, s10, 28672
    s_waitcnt lgkmcnt(0)
    s_waitcnt vmcnt(7)
    v_mfma_f32_32x32x16_bf16 v[112:127], v[180:183], v[232:235], v[112:127]
    s_lshl_b32 s9, s51, 7
    s_add_u32 s10, s10, s9
    s_and_b32 s9, s7, 1
    s_lshl_b32 s9, s9, 6
    s_waitcnt vmcnt(6)
    v_mfma_f32_32x32x16_bf16 v[112:127], v[188:191], v[236:239], v[112:127]
    s_add_u32 s10, s10, s9
    v_bfe_u32 v4, v0, 3, 1
    s_lshr_b32 s8, s7, 1
    v_xor_b32 v4, s8, v4
    v_mfma_f32_32x32x16_bf16 v[96:111], v[192:195], v[172:175], v[96:111]
    v_lshlrev_b32 v4, 6, v4
    v_bfe_u32 v5, v0, 4, 1
    v_lshl_add_u32 v4, v5, 5, v4
    v_and_b32 v5, 3, v0
    v_mfma_f32_32x32x16_bf16 v[96:111], v[200:203], v[40:43], v[96:111]
    v_lshl_add_u32 v4, v5, 3, v4
    v_bfe_u32 v5, v0, 2, 2
    v_lshl_add_u32 v5, v20, 2, v5
    v_lshl_add_u32 v4, v5, 7, v4
    v_mfma_f32_32x32x16_bf16 v[96:111], v[208:211], v[224:227], v[96:111]
    ds_write_b128 v12, v[112:115] offset:32768
    s_and_b32 s8, s7, 1
    s_lshl_b32 s8, s8, 12
    s_add_u32 s8, s8, 148480
    v_add_u32 v4, s8, v4
    v_mfma_f32_32x32x16_bf16 v[96:111], v[216:219], v[228:231], v[96:111]
    ds_write_b128 v12, v[116:119] offset:33792
    v_mfma_f32_32x32x16_bf16 v[96:111], v[176:179], v[232:235], v[96:111]
    ds_write_b128 v12, v[120:123] offset:34816
    v_mfma_f32_32x32x16_bf16 v[96:111], v[184:187], v[236:239], v[96:111]
    ds_write_b128 v12, v[124:127] offset:35840
    s_waitcnt vmcnt(5)
    v_mfma_f32_32x32x16_bf16 v[80:95], v[196:199], v[44:47], v[80:95]
    s_waitcnt vmcnt(4)
    v_mfma_f32_32x32x16_bf16 v[80:95], v[204:207], v[52:55], v[80:95]
    s_nop 6
    ds_write_b128 v12, v[96:99] offset:16384
    s_waitcnt vmcnt(3)
    v_mfma_f32_32x32x16_bf16 v[80:95], v[212:215], v[56:59], v[80:95]
    ds_write_b128 v12, v[100:103] offset:17408
    s_waitcnt vmcnt(2)
    v_mfma_f32_32x32x16_bf16 v[80:95], v[220:223], v[60:63], v[80:95]
    ds_write_b128 v12, v[104:107] offset:18432
    s_waitcnt vmcnt(1)
    v_mfma_f32_32x32x16_bf16 v[80:95], v[180:183], v[240:243], v[80:95]
    ds_write_b128 v12, v[108:111] offset:19456
    s_waitcnt vmcnt(0)
    v_mfma_f32_32x32x16_bf16 v[80:95], v[188:191], v[244:247], v[80:95]
    v_mfma_f32_32x32x16_bf16 v[64:79], v[192:195], v[44:47], v[64:79]
    v_mfma_f32_32x32x16_bf16 v[64:79], v[200:203], v[52:55], v[64:79]
    s_nop 9
    ds_write_b128 v12, v[80:83] offset:0
    ds_write_b128 v12, v[84:87] offset:1024
    v_mfma_f32_32x32x16_bf16 v[64:79], v[208:211], v[56:59], v[64:79]
    ds_write_b128 v12, v[88:91] offset:2048
    ds_write_b128 v12, v[92:95] offset:3072
    v_mfma_f32_32x32x16_bf16 v[64:79], v[216:219], v[60:63], v[64:79]
    s_waitcnt lgkmcnt(0)
    s_barrier
    ds_read_b32 v6, v15
    ds_read_b128 v[108:111], v34 offset:32768
    ds_read_b128 v[104:107], v33 offset:16384
    ds_read_b128 v[96:99], v14 offset:0
    ds_read_b128 v[128:131], v34 offset:33792
    v_mfma_f32_32x32x16_bf16 v[64:79], v[176:179], v[240:243], v[64:79]
    ds_read_b128 v[124:127], v33 offset:17408
    ds_read_b128 v[116:119], v14 offset:1024
    ds_read_b128 v[148:151], v34 offset:34816
    ds_read_b128 v[144:147], v33 offset:18432
    ds_read_b128 v[136:139], v14 offset:2048
    v_mfma_f32_32x32x16_bf16 v[64:79], v[184:187], v[244:247], v[64:79]
    ds_read_b128 v[168:171], v34 offset:35840
    ds_read_b128 v[164:167], v33 offset:19456
    ds_read_b128 v[156:159], v14 offset:3072
    ds_read_b128 v[100:103], v32 offset:0
    ds_read_b64_tr_b16 v[114:115], v4 offset:0
    ds_read_b128 v[120:123], v32 offset:1024
    ds_read_b64_tr_b16 v[134:135], v4 offset:1024
    ds_read_b128 v[140:143], v32 offset:2048
    ds_read_b64_tr_b16 v[154:155], v4 offset:2048
    ds_read_b128 v[160:163], v32 offset:3072
    ds_read_b64_tr_b16 v[174:175], v4 offset:3072
    s_waitcnt lgkmcnt(15)
    v_pk_add_f32 v[104:105], v[104:105], v[108:109]
    v_pk_add_f32 v[106:107], v[106:107], v[110:111]
    s_waitcnt lgkmcnt(14)
    v_pk_add_f32 v[124:125], v[124:125], v[128:129]
    v_pk_add_f32 v[126:127], v[126:127], v[130:131]
    s_waitcnt lgkmcnt(11)
    v_pk_add_f32 v[144:145], v[144:145], v[148:149]
    v_pk_add_f32 v[146:147], v[146:147], v[150:151]
    s_waitcnt lgkmcnt(8)
    v_pk_add_f32 v[164:165], v[164:165], v[168:169]
    v_pk_add_f32 v[166:167], v[166:167], v[170:171]
    v_pk_add_f32 v[64:65], v[64:65], v[104:105]
    v_pk_add_f32 v[66:67], v[66:67], v[106:107]
    v_pk_add_f32 v[68:69], v[68:69], v[124:125]
    v_pk_add_f32 v[70:71], v[70:71], v[126:127]
    v_pk_add_f32 v[72:73], v[72:73], v[144:145]
    v_pk_add_f32 v[74:75], v[74:75], v[146:147]
    v_pk_add_f32 v[76:77], v[76:77], v[164:165]
    v_pk_add_f32 v[78:79], v[78:79], v[166:167]
    s_waitcnt lgkmcnt(6)
    v_lshlrev_b32 v112, 16, v114
    v_and_b32 v113, 0xffff0000, v114
    v_lshlrev_b32 v114, 16, v115
    v_and_b32 v115, 0xffff0000, v115
    v_pk_add_f32 v[64:65], v[64:65], v[100:101]
    v_pk_add_f32 v[66:67], v[66:67], v[102:103]
    v_pk_add_f32 v[96:97], v[96:97], v[112:113]
    v_pk_add_f32 v[98:99], v[98:99], v[114:115]
    v_pk_fma_f32 v[64:65], v[64:65], v[6:7], v[96:97] op_sel_hi:[1,0,1]
    v_pk_fma_f32 v[66:67], v[66:67], v[6:7], v[98:99] op_sel_hi:[1,0,1]
    v_cvt_pk_bf16_f32 v80, v64, v65
    v_cvt_pk_bf16_f32 v81, v66, v67
    s_waitcnt lgkmcnt(4)
    v_lshlrev_b32 v132, 16, v134
    v_and_b32 v133, 0xffff0000, v134
    v_lshlrev_b32 v134, 16, v135
    v_and_b32 v135, 0xffff0000, v135
    v_pk_add_f32 v[68:69], v[68:69], v[120:121]
    v_pk_add_f32 v[70:71], v[70:71], v[122:123]
    v_pk_add_f32 v[116:117], v[116:117], v[132:133]
    v_pk_add_f32 v[118:119], v[118:119], v[134:135]
    v_pk_fma_f32 v[68:69], v[68:69], v[6:7], v[116:117] op_sel_hi:[1,0,1]
    v_pk_fma_f32 v[70:71], v[70:71], v[6:7], v[118:119] op_sel_hi:[1,0,1]
    v_cvt_pk_bf16_f32 v82, v68, v69
    v_cvt_pk_bf16_f32 v83, v70, v71
    s_nop 0
    v_permlane32_swap_b32 v80, v82
    v_permlane32_swap_b32 v81, v83
    buffer_store_dwordx4 v[80:83], v23, s[68:71], s10 offen offset:0
    s_waitcnt lgkmcnt(2)
    v_lshlrev_b32 v152, 16, v154
    v_and_b32 v153, 0xffff0000, v154
    v_lshlrev_b32 v154, 16, v155
    v_and_b32 v155, 0xffff0000, v155
    v_pk_add_f32 v[72:73], v[72:73], v[140:141]
    v_pk_add_f32 v[74:75], v[74:75], v[142:143]
    v_pk_add_f32 v[136:137], v[136:137], v[152:153]
    v_pk_add_f32 v[138:139], v[138:139], v[154:155]
    v_pk_fma_f32 v[72:73], v[72:73], v[6:7], v[136:137] op_sel_hi:[1,0,1]
    v_pk_fma_f32 v[74:75], v[74:75], v[6:7], v[138:139] op_sel_hi:[1,0,1]
    v_cvt_pk_bf16_f32 v84, v72, v73
    v_cvt_pk_bf16_f32 v85, v74, v75
    s_waitcnt lgkmcnt(0)
    v_lshlrev_b32 v172, 16, v174
    v_and_b32 v173, 0xffff0000, v174
    v_lshlrev_b32 v174, 16, v175
    v_and_b32 v175, 0xffff0000, v175
    v_pk_add_f32 v[76:77], v[76:77], v[160:161]
    v_pk_add_f32 v[78:79], v[78:79], v[162:163]
    v_pk_add_f32 v[156:157], v[156:157], v[172:173]
    v_pk_add_f32 v[158:159], v[158:159], v[174:175]
    v_pk_fma_f32 v[76:77], v[76:77], v[6:7], v[156:157] op_sel_hi:[1,0,1]
    v_pk_fma_f32 v[78:79], v[78:79], v[6:7], v[158:159] op_sel_hi:[1,0,1]
    v_cvt_pk_bf16_f32 v86, v76, v77
    v_cvt_pk_bf16_f32 v87, v78, v79
    s_nop 0
    v_permlane32_swap_b32 v84, v86
    v_permlane32_swap_b32 v85, v87
    buffer_store_dwordx4 v[84:87], v23, s[68:71], s10 offen offset:32
    s_endpgm
L_GH:
    s_mov_b32 s60, s40
    s_and_b32 s61, s41, 0xffff
    s_mov_b32 s62, 1605632
    s_mov_b32 s63, 0x20000
    v_lshlrev_b32 v1, 2, v0
    v_add_u32 v1, 158848, v1
    v_mov_b32 v2, 157696
    v_cmp_eq_u32 vcc, 0, v0
    s_nop 1
    v_cndmask_b32 v1, v1, v2, vcc
    v_mov_b32 v2, 1
    s_mov_b32 s64, s48
    s_and_b32 s65, s49, 0xffff
    s_mov_b32 s66, 33554432
    s_mov_b32 s67, 0x20000
    v_mov_b32 v85, 0x3f803f80
    v_mov_b32 v86, 0x00003f80
    v_mov_b32 v87, 0x3f800000
    s_mul_i32 s8, s7, 1920
    s_add_u32 s8, s8, 148480
    v_mul_u32_u24 v82, 960, v80
    v_lshl_add_u32 v82, v81, 4, v82
    v_add_u32 v82, s8, v82
    v_lshlrev_b32 v80, 3, v80
    v_bfe_u32 v84, v0, 2, 2
    v_mul_u32_u24 v83, 960, v84
    v_lshrrev_b32 v84, 4, v0
    v_lshl_add_u32 v83, v84, 5, v83
    v_and_b32 v84, 3, v0
    v_lshl_add_u32 v83, v84, 3, v83
    s_lshl_b32 s8, s7, 7
    s_add_u32 s8, s8, 148480
    v_add_u32 v83, s8, v83
    v_lshrrev_b32 v81, 3, v0
    v_lshlrev_b32 v81, 15, v81
    v_and_b32 v84, 7, v0
    v_lshl_add_u32 v81, v84, 4, v81
    s_lshl_b32 s95, s95, 4
    s_add_u32 s95, s95, 16384
    s_lshl_b32 s97, s7, 18
    s_lshl_b32 s9, s96, 7
    s_add_u32 s97, s97, s9
    s_add_u32 s97, s97, 1048576
    s_add_u32 s28, s97, 1048576
    s_cmp_eq_u32 s7, 3
    s_cselect_b32 s28, 33554432, s28
    s_lshl_b32 s96, s96, 2
    s_lshl_b32 s8, s7, 10
    s_add_u32 s96, s96, s8
    s_add_u32 s29, s96, 393216
    s_waitcnt lgkmcnt(0)
    s_add_u32 s6, s6, 2654435769
    v_min_u32 v22, 1, v0
    v_lshlrev_b32 v22, 30, v22
    v_mov_b32 v23, s6
    v_mov_b32 v93, v23
    ds_write_b32 v1, v23 offset:128
    s_waitcnt vmcnt(0)
    v_dot2_f32_bf16 v88, v64, v85, 0
    v_dot2_f32_bf16 v89, v64, v64, 0
    v_dot2_f32_bf16 v88, v65, v85, v88
    v_dot2_f32_bf16 v89, v65, v65, v89
    v_dot2_f32_bf16 v88, v66, v85, v88
    v_dot2_f32_bf16 v89, v66, v66, v89
    v_dot2_f32_bf16 v88, v67, v85, v88
    v_dot2_f32_bf16 v89, v67, v67, v89
    v_dot2_f32_bf16 v88, v68, v85, v88
    v_dot2_f32_bf16 v89, v68, v68, v89
    v_dot2_f32_bf16 v88, v69, v85, v88
    v_dot2_f32_bf16 v89, v69, v69, v89
    v_dot2_f32_bf16 v88, v70, v85, v88
    v_dot2_f32_bf16 v89, v70, v70, v89
    v_dot2_f32_bf16 v88, v71, v85, v88
    v_dot2_f32_bf16 v89, v71, v71, v89
    s_nop 1
    v_add_f32_dpp v88, v88, v88 row_ror:8 row_mask:0xf bank_mask:0xf
    v_add_f32_dpp v89, v89, v89 row_ror:8 row_mask:0xf bank_mask:0xf
    s_nop 0
    v_add_f32_dpp v88, v88, v88 row_ror:4 row_mask:0xf bank_mask:0xf
    v_add_f32_dpp v89, v89, v89 row_ror:4 row_mask:0xf bank_mask:0xf
    s_nop 0
    v_add_f32_dpp v88, v88, v88 row_ror:2 row_mask:0xf bank_mask:0xf
    v_add_f32_dpp v89, v89, v89 row_ror:2 row_mask:0xf bank_mask:0xf
    s_nop 0
    v_add_f32_dpp v88, v88, v88 row_ror:1 row_mask:0xf bank_mask:0xf
    v_add_f32_dpp v89, v89, v89 row_ror:1 row_mask:0xf bank_mask:0xf
    v_mov_b32 v90, v88
    v_mov_b32 v91, v89
    s_nop 0
    v_permlane16_swap_b32 v88, v90
    v_permlane16_swap_b32 v89, v91
    v_add_f32 v88, v88, v90
    v_add_f32 v89, v89, v91
    v_mul_f32 v88, 0xbb124925, v88
    v_mul_f32 v89, 0x3b124925, v89
    v_fma_f32 v89, -v88, v88, v89
    v_cvt_pk_bf16_f32 v88, v88, v88
    v_and_b32 v88, 0xffff0000, v88
    v_max_f32 v89, 0, v89
    v_dot2_f32_bf16 v96, v64, v86, v88
    v_dot2_f32_bf16 v97, v64, v87, v88
    v_cvt_pk_bf16_f32 v89, v89, v89
    v_dot2_f32_bf16 v98, v65, v86, v88
    v_dot2_f32_bf16 v99, v65, v87, v88
    v_and_b32 v89, 0xffff0000, v89
    v_dot2_f32_bf16 v100, v66, v86, v88
    v_dot2_f32_bf16 v101, v66, v87, v88
    v_add_f32 v89, 0x3727c5ac, v89
    v_dot2_f32_bf16 v102, v67, v86, v88
    v_dot2_f32_bf16 v103, v67, v87, v88
    v_cvt_pk_bf16_f32 v89, v89, v89
    v_dot2_f32_bf16 v104, v68, v86, v88
    v_dot2_f32_bf16 v105, v68, v87, v88
    v_and_b32 v89, 0xffff0000, v89
    v_dot2_f32_bf16 v106, v69, v86, v88
    v_dot2_f32_bf16 v107, v69, v87, v88
    v_sqrt_f32 v89, v89
    v_dot2_f32_bf16 v108, v70, v86, v88
    v_dot2_f32_bf16 v109, v70, v87, v88
    v_cvt_pk_bf16_f32 v89, v89, v89
    v_dot2_f32_bf16 v110, v71, v86, v88
    v_dot2_f32_bf16 v111, v71, v87, v88
    v_and_b32 v89, 0xffff0000, v89
    v_rcp_f32 v90, v89
    v_cvt_pk_bf16_f32 v92, v88, v89
    s_mov_b32 exec_lo, 1
    s_mov_b32 exec_hi, 1
    buffer_store_dwordx2 v[92:93], v80, s[64:67], s95 offen sc1
    s_mov_b64 exec, -1
    v_cvt_pk_bf16_f32 v64, v96, v97
    v_cvt_pk_bf16_f32 v65, v98, v99
    v_cvt_pk_bf16_f32 v66, v100, v101
    v_cvt_pk_bf16_f32 v67, v102, v103
    v_cvt_pk_bf16_f32 v68, v104, v105
    v_cvt_pk_bf16_f32 v69, v106, v107
    v_cvt_pk_bf16_f32 v70, v108, v109
    v_cvt_pk_bf16_f32 v71, v110, v111
    v_lshlrev_b32 v96, 16, v64
    v_and_b32 v97, 0xffff0000, v64
    v_mul_f32 v96, v90, v96
    v_mul_f32 v97, v90, v97
    v_cvt_pk_bf16_f32 v64, v96, v97
    v_lshlrev_b32 v98, 16, v65
    v_and_b32 v99, 0xffff0000, v65
    v_mul_f32 v98, v90, v98
    v_mul_f32 v99, v90, v99
    v_cvt_pk_bf16_f32 v65, v98, v99
    v_lshlrev_b32 v100, 16, v66
    v_and_b32 v101, 0xffff0000, v66
    v_mul_f32 v100, v90, v100
    v_mul_f32 v101, v90, v101
    v_cvt_pk_bf16_f32 v66, v100, v101
    v_lshlrev_b32 v102, 16, v67
    v_and_b32 v103, 0xffff0000, v67
    v_mul_f32 v102, v90, v102
    v_mul_f32 v103, v90, v103
    v_cvt_pk_bf16_f32 v67, v102, v103
    ds_write_b128 v82, v[64:67]
    v_lshlrev_b32 v104, 16, v68
    v_and_b32 v105, 0xffff0000, v68
    v_mul_f32 v104, v90, v104
    v_mul_f32 v105, v90, v105
    v_cvt_pk_bf16_f32 v68, v104, v105
    v_lshlrev_b32 v106, 16, v69
    v_and_b32 v107, 0xffff0000, v69
    v_mul_f32 v106, v90, v106
    v_mul_f32 v107, v90, v107
    v_cvt_pk_bf16_f32 v69, v106, v107
    v_lshlrev_b32 v108, 16, v70
    v_and_b32 v109, 0xffff0000, v70
    v_mul_f32 v108, v90, v108
    v_mul_f32 v109, v90, v109
    v_cvt_pk_bf16_f32 v70, v108, v109
    v_lshlrev_b32 v110, 16, v71
    v_and_b32 v111, 0xffff0000, v71
    v_mul_f32 v110, v90, v110
    v_mul_f32 v111, v90, v111
    v_cvt_pk_bf16_f32 v71, v110, v111
    s_mov_b64 exec, s[98:99]
    ds_write_b128 v82, v[68:71] offset:512
    s_mov_b64 exec, -1
    s_waitcnt lgkmcnt(0)
    s_barrier
    ds_read_b64_tr_b16 v[224:225], v83
    ds_read_b64_tr_b16 v[226:227], v83 offset:3840
    ds_read_b64_tr_b16 v[228:229], v83 offset:512
    ds_read_b64_tr_b16 v[230:231], v83 offset:4352
    v_mov_b32 v232, v81
    s_waitcnt lgkmcnt(2)
    buffer_store_dwordx4 v[224:227], v232, s[64:67], s97 offen sc1
    s_waitcnt lgkmcnt(0)
    buffer_store_dwordx4 v[228:231], v232, s[64:67], s28 offen sc1
    s_lshl_b32 s30, s4, 2
    s_add_u32 s30, s30, s5
    s_sub_u32 s30, s30, 28
    s_lshl_b32 s8, s3, 5
    s_add_u32 s30, s30, s8
    s_cmp_gt_u32 s3, 4
    s_cselect_b32 s8, 32, 0
    s_sub_u32 s30, s30, s8
    s_min_u32 s30, s30, 195
    s_mul_i32 s8, s30, 2341
    s_lshr_b32 s8, s8, 16
    s_mul_i32 s9, s8, 28
    s_sub_u32 s9, s30, s9
    s_mul_i32 s31, s9, 9363
    s_lshr_b32 s31, s31, 16
    s_mul_i32 s31, s31, 7
    s_add_u32 s31, s31, s9
    s_mul_i32 s31, s31, 28672
    s_lshl_b32 s8, s8, 7
    s_add_u32 s31, s31, s8
    v_lshrrev_b32 v40, 3, v0
    v_and_b32 v41, 7, v0
    v_mul_u32_u24 v40, 896, v40
    v_bfe_u32 v42, v0, 4, 1
    v_lshlrev_b32 v42, 2, v42
    v_xor_b32 v42, v42, v41
    v_lshl_add_u32 v40, v42, 4, v40
    s_lshl_b32 s34, s3, 12
    s_add_u32 s34, s34, 16384
    s_mov_b32 m0, s34
    s_nop 0
    buffer_load_dwordx4 v40, s[60:63], s31 offen offset:0 lds
    s_add_u32 s31, s31, 6144
    buffer_load_dwordx4 v40, s[60:63], s31 offen offset:1024 lds
    s_add_u32 s31, s31, 6144
    buffer_load_dwordx4 v40, s[60:63], s31 offen offset:2048 lds
    s_add_u32 s31, s31, 6144
    buffer_load_dwordx4 v40, s[60:63], s31 offen offset:3072 lds
    s_waitcnt vmcnt(4)
    buffer_store_dword v23, v22, s[64:67], s29 offen sc1
    v_bfe_u32 v40, v0, 2, 2
    v_and_b32 v41, 3, v0
    v_lshrrev_b32 v42, 5, v0
    v_bfe_u32 v43, v0, 4, 1
    v_lshlrev_b32 v43, 5, v43
    v_lshl_add_u32 v43, v41, 3, v43
    v_lshl_add_u32 v42, v42, 2, v40
    v_lshl_add_u32 v42, v42, 7, v43
    v_add_u32 v42, s34, v42
    v_lshrrev_b32 v40, 1, v40
    v_lshl_add_u32 v42, v40, 6, v42
    v_xor_b32 v43, 64, v42
    v_lshlrev_b32 v44, 4, v0
    s_mul_i32 s8, s30, 9363
    s_lshr_b32 s8, s8, 16
    s_mul_i32 s9, s8, 7
    s_sub_u32 s9, s30, s9
    s_mul_i32 s31, s9, 114688
    s_lshl_b32 s8, s8, 7
    s_add_u32 s31, s31, s8
    s_add_u32 s31, s31, 3145728
    s_lshl_b32 s30, s30, 7
    s_add_u32 s30, s30, 458752
    v_lshrrev_b32 v44, 3, v0
    v_mul_u32_u24 v44, 3584, v44
    v_and_b32 v45, 7, v0
    v_lshl_add_u32 v44, v45, 4, v44
    s_waitcnt vmcnt(1)
    ds_read_b64_tr_b16 v[128:129], v42 offset:0
    ds_read_b64_tr_b16 v[130:131], v42 offset:1024
    ds_read_b64_tr_b16 v[132:133], v43 offset:0
    ds_read_b64_tr_b16 v[134:135], v43 offset:1024
    ds_read_b64_tr_b16 v[136:137], v42 offset:2048
    ds_read_b64_tr_b16 v[138:139], v42 offset:3072
    ds_read_b64_tr_b16 v[140:141], v43 offset:2048
    ds_read_b64_tr_b16 v[142:143], v43 offset:3072
    s_waitcnt lgkmcnt(6)
    buffer_store_dwordx4 v[128:131], v44, s[64:67], s31 offen sc1
    s_add_u32 s31, s31, 28672
    s_waitcnt lgkmcnt(4)
    buffer_store_dwordx4 v[132:135], v44, s[64:67], s31 offen sc1
    s_add_u32 s31, s31, 28672
    s_waitcnt lgkmcnt(2)
    buffer_store_dwordx4 v[136:139], v44, s[64:67], s31 offen sc1
    s_add_u32 s31, s31, 28672
    s_waitcnt lgkmcnt(0)
    buffer_store_dwordx4 v[140:143], v44, s[64:67], s31 offen sc1
    s_add_u32 s31, s31, 28672
    v_lshrrev_b32 v22, 5, v0
    v_lshlrev_b32 v22, 30, v22
    v_lshl_add_u32 v22, v0, 2, v22
    v_and_b32 v45, 31, v0
    v_lshlrev_b32 v45, 7, v45
    s_waitcnt vmcnt(0)
    buffer_store_dword v23, v22, s[64:67], s30 offen sc1
    s_cmp_lg_u32 s2, 255
    s_cbranch_scc1 L_GHX
    s_cmp_lg_u32 s7, 0
    s_cbranch_scc1 L_GHX
    v_lshlrev_b32 v28, 4, v0
    s_mov_b32 s15, 393216
Lg_6:
    s_sleep 100
    buffer_load_dwordx4 v[32:35], v28, s[64:67], s15 offen sc1
    s_waitcnt vmcnt(0)
    v_cmp_ne_u32 vcc, s6, v32
    v_cmp_ne_u32 s[8:9], s6, v33
    s_or_b64 vcc, vcc, s[8:9]
    v_cmp_ne_u32 s[8:9], s6, v34
    s_or_b64 vcc, vcc, s[8:9]
    v_cmp_ne_u32 s[8:9], s6, v35
    s_or_b64 vcc, vcc, s[8:9]
    s_cmp_eq_u64 vcc, 0
    s_cbranch_scc0 Lg_6r
    s_mov_b32 s15, 0
    buffer_store_dword v23, v22, s[64:67], s15 offen sc1
    s_endpgm
L_GHX:
    s_mov_b64 exec, -1
    s_branch L_HP
La_3s:
    s_sleep 4
    buffer_load_dwordx2 v[26:27], v17, s[64:67], s26 offen sc1
    buffer_load_dwordx2 v[28:29], v18, s[64:67], s27 offen sc1
    buffer_load_dwordx2 v[30:31], v18, s[64:67], s27 offen offset:256 sc1
    s_waitcnt vmcnt(0)
    s_branch La_3r
La_4s:
    s_sleep 8
    buffer_load_dword v32, v19, s[64:67], s21 offen sc1
    s_waitcnt vmcnt(0)
    s_branch La_4r
La_5s:
    s_sleep 4
    buffer_load_dword v24, v19, s[64:67], s13 offen sc1
    s_waitcnt vmcnt(0)
    s_branch La_5r
Lg_6r:
    s_add_u32 s100, s100, 1
    s_cmp_lt_u32 s100, 400000
    s_cbranch_scc1 Lg_6
    s_endpgm
La_3r:
    s_add_u32 s100, s100, 1
    s_cmp_lt_u32 s100, 400000
    s_cbranch_scc1 La_3
    s_endpgm
La_4r:
    s_add_u32 s100, s100, 1
    s_cmp_lt_u32 s100, 400000
    s_cbranch_scc1 La_4
    s_endpgm
La_5r:
    s_add_u32 s100, s100, 1
    s_cmp_lt_u32 s100, 400000
    s_cbranch_scc1 La_5
    s_endpgm
L_S:
    v_lshrrev_b32 v25, 4, v0
    v_and_b32 v24, 15, v0
    v_lshlrev_b32 v1, 2, v0
    v_add_u32 v1, 158848, v1
    v_mov_b32 v2, 157696
    v_cmp_eq_u32 vcc, 0, v0
    s_nop 1
    v_cndmask_b32 v1, v1, v2, vcc
    v_mov_b32 v2, 1
    s_lshr_b32 s12, s7, 1
    s_and_b32 s13, s7, 1
    s_mov_b32 s64, s48
    s_and_b32 s65, s49, 0xffff
    s_mov_b32 s66, 33554432
    s_mov_b32 s67, 0x20000
    s_mov_b32 s52, s16
    s_and_b32 s53, s17, 0xffff
    s_mov_b32 s54, 1835008
    s_mov_b32 s55, 0x20000
    s_mul_i32 s51, s7, 8448
    s_add_u32 s51, s51, 114688
    v_and_b32 v70, 1, v25
    v_lshl_add_u32 v4, v70, 8, s51
    v_lshrrev_b32 v70, 5, v0
    v_lshl_add_u32 v4, v70, 7, v4
    v_mul_u32_u24 v5, 528, v24
    v_add_u32 v5, v5, v4
    v_lshl_add_u32 v4, v24, 3, v4
    v_lshlrev_b32 v6, 5, v24
    v_lshl_add_u32 v6, v25, 4, v6
    v_lshlrev_b32 v72, 4, v24
    v_add_u32 v72, 1024, v72
    v_cmp_eq_u32 vcc, 2, v25
    v_mov_b32 v73, 512
    v_mov_b32 v74, 256
    v_cndmask_b32 v6, v6, v72, vcc
    v_cndmask_b32 v73, v73, v74, vcc
    v_lshlrev_b32 v72, 3, v24
    v_add_u32 v72, 1536, v72
    v_cmp_eq_u32 vcc, 3, v25
    v_mov_b32 v75, 128
    v_lshlrev_b32 v8, 2, v24
    v_cndmask_b32 v6, v6, v72, vcc
    v_cndmask_b32 v73, v73, v75, vcc
    v_cndmask_b32 v74, 8, v74, vcc
    v_add_u32 v6, s51, v6
    v_add_u32 v7, v6, v74
    v_add_u32 v9, v6, v73
    v_add_u32 v10, v7, v73
    v_lshl_add_u32 v8, v25, 9, v8
    v_add_u32 v8, s51, v8
    s_lshl_b32 s8, s12, 2
    v_add_u32 v29, s8, v1
    v_mov_b32 v97, 0
    v_mov_b32 v98, 0
    v_mov_b32 v99, 0
    s_waitcnt lgkmcnt(0)
    s_lshl_b32 s8, s12, 4
    s_lshr_b32 s15, s15, s8
    s_lshl_b32 s15, s15, 16
    s_lshr_b32 s50, s50, s8
    s_lshl_b32 s50, s50, 16
    s_lshr_b32 s101, s101, s8
    s_lshl_b32 s101, s101, 16
    s_cmp_eq_u32 s13, 0
    s_cselect_b32 s8, s50, 0
    s_cselect_b32 s101, s101, 0
    v_mov_b32 v70, s8
    v_cmp_eq_u32 vcc, 0, v0
    s_mov_b32 s8, 0x3fb8aa3b
    s_mov_b32 s9, 0x32a5705f
    v_mov_b32 v19, s15
    v_cndmask_b32 v96, 0, v70, vcc
    v_mul_f32 v20, s8, v19
    v_exp_f32 v18, v20
    v_fma_f32 v21, v19, s8, -v20
    v_fma_f32 v21, v19, s9, v21
    v_mul_f32 v21, 0x3f317218, v21
    v_fma_f32 v18, v18, v21, v18
    v_cvt_pk_bf16_f32 v18, v18, v18
    v_and_b32 v18, 0xffff0000, v18
    s_waitcnt vmcnt(0)
    v_lshlrev_b32 v88, 16, v12
    v_lshlrev_b32 v89, 16, v13
    v_mul_f32 v88, v18, v88
    v_mul_f32 v89, v18, v89
    v_mul_f32 v88, s8, v88
    v_mul_f32 v89, 0.15915494, v89
    v_mul_f32 v74, 0x43800000, v88
    v_mul_f32 v72, 0x43800000, v89
    v_exp_f32 v74, v74
    v_fract_f32 v72, v72
    v_cos_f32 v73, v72
    v_sin_f32 v72, v72
    v_mul_f32 v38, v74, v73
    v_mul_f32 v40, v74, v72
    v_sub_f32 v39, 0, v40
    v_lshlrev_b32 v70, 16, v14
    v_lshlrev_b32 v71, 16, v15
    v_lshlrev_b32 v72, 16, v16
    v_lshlrev_b32 v73, 16, v17
    v_mul_f32 v70, v18, v70
    v_mul_f32 v71, v18, v71
    v_mul_f32 v50, v72, v70
    v_mul_f32 v51, v72, v71
    v_fma_f32 v50, -v73, v71, v50
    v_fma_f32 v51, -v73, v70, -v51
    v_and_b32 v90, 0xffff0000, v12
    v_and_b32 v91, 0xffff0000, v13
    v_mul_f32 v90, v18, v90
    v_mul_f32 v91, v18, v91
    v_mul_f32 v90, s8, v90
    v_mul_f32 v91, 0.15915494, v91
    v_mul_f32 v74, 0x43800000, v90
    v_mul_f32 v72, 0x43800000, v91
    v_exp_f32 v74, v74
    v_fract_f32 v72, v72
    v_cos_f32 v73, v72
    v_sin_f32 v72, v72
    v_mul_f32 v47, v74, v73
    v_mul_f32 v49, v74, v72
    v_sub_f32 v48, 0, v49
    v_and_b32 v70, 0xffff0000, v14
    v_and_b32 v71, 0xffff0000, v15
    v_and_b32 v72, 0xffff0000, v16
    v_and_b32 v73, 0xffff0000, v17
    v_mul_f32 v70, v18, v70
    v_mul_f32 v71, v18, v71
    v_mul_f32 v52, v72, v70
    v_mul_f32 v53, v72, v71
    v_fma_f32 v52, -v73, v71, v52
    v_fma_f32 v53, -v73, v70, -v53
    v_mul_f32 v62, v50, v38
    v_mul_f32 v63, v50, v39
    v_mul_f32 v64, v52, v47
    v_mul_f32 v65, v52, v48
    v_fmac_f32 v62, v51, v40
    v_fmac_f32 v63, v51, v38
    v_fmac_f32 v64, v53, v49
    v_fmac_f32 v65, v53, v47
    v_cvt_pk_bf16_f32 v208, v62, v63
    v_cvt_pk_bf16_f32 v209, v64, v65
    ds_write_b64 v4, v[208:209] offset:4224
    v_mul_f32 v66, v62, v38
    v_mul_f32 v67, v62, v39
    v_mul_f32 v68, v64, v47
    v_mul_f32 v69, v64, v48
    v_fmac_f32 v66, v63, v40
    v_fmac_f32 v67, v63, v38
    v_fmac_f32 v68, v65, v49
    v_fmac_f32 v69, v65, v47
    v_cvt_pk_bf16_f32 v216, v66, v67
    v_cvt_pk_bf16_f32 v217, v68, v69
    ds_write_b64 v4, v[216:217] offset:6336
    v_mul_f32 v62, v66, v38
    v_mul_f32 v63, v66, v39
    v_mul_f32 v64, v68, v47
    v_mul_f32 v65, v68, v48
    v_fmac_f32 v62, v67, v40
    v_fmac_f32 v63, v67, v38
    v_fmac_f32 v64, v69, v49
    v_fmac_f32 v65, v69, v47
    v_cvt_pk_bf16_f32 v220, v62, v63
    v_cvt_pk_bf16_f32 v221, v64, v65
    ds_write_b64 v4, v[220:221] offset:7392
    v_mul_f32 v66, v62, v38
    v_mul_f32 v67, v62, v39
    v_mul_f32 v68, v64, v47
    v_mul_f32 v69, v64, v48
    v_fmac_f32 v66, v63, v40
    v_fmac_f32 v67, v63, v38
    v_fmac_f32 v68, v65, v49
    v_fmac_f32 v69, v65, v47
    v_cvt_pk_bf16_f32 v224, v66, v67
    v_cvt_pk_bf16_f32 v225, v68, v69
    ds_write_b64 v4, v[224:225] offset:0
    v_mul_f32 v62, v66, v38
    v_mul_f32 v63, v66, v39
    v_mul_f32 v64, v68, v47
    v_mul_f32 v65, v68, v48
    v_fmac_f32 v62, v67, v40
    v_fmac_f32 v63, v67, v38
    v_fmac_f32 v64, v69, v49
    v_fmac_f32 v65, v69, v47
    v_cvt_pk_bf16_f32 v226, v62, v63
    v_cvt_pk_bf16_f32 v227, v64, v65
    ds_write_b64 v4, v[226:227] offset:528
    v_mul_f32 v66, v62, v38
    v_mul_f32 v67, v62, v39
    v_mul_f32 v68, v64, v47
    v_mul_f32 v69, v64, v48
    v_fmac_f32 v66, v63, v40
    v_fmac_f32 v67, v63, v38
    v_fmac_f32 v68, v65, v49
    v_fmac_f32 v69, v65, v47
    v_cvt_pk_bf16_f32 v228, v66, v67
    v_cvt_pk_bf16_f32 v229, v68, v69
    ds_write_b64 v4, v[228:229] offset:1056
    v_mul_f32 v62, v66, v38
    v_mul_f32 v63, v66, v39
    v_mul_f32 v64, v68, v47
    v_mul_f32 v65, v68, v48
    v_fmac_f32 v62, v67, v40
    v_fmac_f32 v63, v67, v38
    v_fmac_f32 v64, v69, v49
    v_fmac_f32 v65, v69, v47
    v_cvt_pk_bf16_f32 v230, v62, v63
    v_cvt_pk_bf16_f32 v231, v64, v65
    ds_write_b64 v4, v[230:231] offset:1584
    v_mul_f32 v66, v62, v38
    v_mul_f32 v67, v62, v39
    v_mul_f32 v68, v64, v47
    v_mul_f32 v69, v64, v48
    v_fmac_f32 v66, v63, v40
    v_fmac_f32 v67, v63, v38
    v_fmac_f32 v68, v65, v49
    v_fmac_f32 v69, v65, v47
    v_cvt_pk_bf16_f32 v232, v66, v67
    v_cvt_pk_bf16_f32 v233, v68, v69
    ds_write_b64 v4, v[232:233] offset:2112
    ds_read_b128 v[224:227], v5 offset:0
    ds_read_b128 v[228:231], v5 offset:16
    ds_read_b128 v[232:235], v5 offset:32
    ds_read_b128 v[236:239], v5 offset:48
    ds_read_b128 v[240:243], v5 offset:64
    ds_read_b128 v[244:247], v5 offset:80
    ds_read_b128 v[248:251], v5 offset:96
    ds_read_b128 v[252:255], v5 offset:112
    v_exp_f32 v74, v88
    v_fract_f32 v72, v89
    v_cos_f32 v73, v72
    v_sin_f32 v72, v72
    v_mul_f32 v32, v74, v73
    v_mul_f32 v34, v74, v72
    v_sub_f32 v33, 0, v34
    v_exp_f32 v74, v90
    v_fract_f32 v72, v91
    v_cos_f32 v73, v72
    v_sin_f32 v72, v72
    v_mul_f32 v41, v74, v73
    v_mul_f32 v43, v74, v72
    v_sub_f32 v42, 0, v43
    v_cvt_pk_bf16_f32 v192, v50, v51
    v_cvt_pk_bf16_f32 v193, v52, v53
    ds_write_b64 v4, v[192:193] offset:0
    v_mul_f32 v54, v50, v32
    v_mul_f32 v55, v50, v33
    v_mul_f32 v56, v52, v41
    v_mul_f32 v57, v52, v42
    v_fmac_f32 v54, v51, v34
    v_fmac_f32 v55, v51, v32
    v_fmac_f32 v56, v53, v43
    v_fmac_f32 v57, v53, v41
    v_cvt_pk_bf16_f32 v194, v54, v55
    v_cvt_pk_bf16_f32 v195, v56, v57
    ds_write_b64 v4, v[194:195] offset:528
    v_mul_f32 v50, v54, v32
    v_mul_f32 v51, v54, v33
    v_mul_f32 v52, v56, v41
    v_mul_f32 v53, v56, v42
    v_fmac_f32 v50, v55, v34
    v_fmac_f32 v51, v55, v32
    v_fmac_f32 v52, v57, v43
    v_fmac_f32 v53, v57, v41
    v_cvt_pk_bf16_f32 v196, v50, v51
    v_cvt_pk_bf16_f32 v197, v52, v53
    ds_write_b64 v4, v[196:197] offset:1056
    v_mul_f32 v58, v50, v38
    v_mul_f32 v59, v50, v39
    v_mul_f32 v60, v52, v47
    v_mul_f32 v61, v52, v48
    v_fmac_f32 v58, v51, v40
    v_fmac_f32 v59, v51, v38
    v_fmac_f32 v60, v53, v49
    v_fmac_f32 v61, v53, v47
    v_cvt_pk_bf16_f32 v210, v58, v59
    v_cvt_pk_bf16_f32 v211, v60, v61
    ds_write_b64 v4, v[210:211] offset:4752
    v_mul_f32 v54, v50, v32
    v_mul_f32 v55, v50, v33
    v_mul_f32 v56, v52, v41
    v_mul_f32 v57, v52, v42
    v_fmac_f32 v54, v51, v34
    v_fmac_f32 v55, v51, v32
    v_fmac_f32 v56, v53, v43
    v_fmac_f32 v57, v53, v41
    v_cvt_pk_bf16_f32 v198, v54, v55
    v_cvt_pk_bf16_f32 v199, v56, v57
    ds_write_b64 v4, v[198:199] offset:1584
    v_mul_f32 v50, v54, v32
    v_mul_f32 v51, v54, v33
    v_mul_f32 v52, v56, v41
    v_mul_f32 v53, v56, v42
    v_fmac_f32 v50, v55, v34
    v_fmac_f32 v51, v55, v32
    v_fmac_f32 v52, v57, v43
    v_fmac_f32 v53, v57, v41
    v_cvt_pk_bf16_f32 v200, v50, v51
    v_cvt_pk_bf16_f32 v201, v52, v53
    ds_write_b64 v4, v[200:201] offset:2112
    v_mul_f32 v66, v50, v38
    v_mul_f32 v67, v50, v39
    v_mul_f32 v68, v52, v47
    v_mul_f32 v69, v52, v48
    v_fmac_f32 v66, v51, v40
    v_fmac_f32 v67, v51, v38
    v_fmac_f32 v68, v53, v49
    v_fmac_f32 v69, v53, v47
    v_cvt_pk_bf16_f32 v212, v66, v67
    v_cvt_pk_bf16_f32 v213, v68, v69
    ds_write_b64 v4, v[212:213] offset:5280
    v_mul_f32 v54, v50, v32
    v_mul_f32 v55, v50, v33
    v_mul_f32 v56, v52, v41
    v_mul_f32 v57, v52, v42
    v_fmac_f32 v54, v51, v34
    v_fmac_f32 v55, v51, v32
    v_fmac_f32 v56, v53, v43
    v_fmac_f32 v57, v53, v41
    v_cvt_pk_bf16_f32 v202, v54, v55
    v_cvt_pk_bf16_f32 v203, v56, v57
    ds_write_b64 v4, v[202:203] offset:2640
    s_barrier
    s_lshl_b32 s8, s14, 2
    s_add_u32 s8, s8, s7
    s_mul_i32 s8, s8, 1792
    v_min_u32 v120, 13, v0
    v_lshl_add_u32 v120, v120, 7, s8
    global_load_dword v123, v120, s[40:41]
    v_mul_f32 v50, v54, v32
    v_mul_f32 v51, v54, v33
    v_mul_f32 v52, v56, v41
    v_mul_f32 v53, v56, v42
    v_fmac_f32 v50, v55, v34
    v_fmac_f32 v51, v55, v32
    v_fmac_f32 v52, v57, v43
    v_fmac_f32 v53, v57, v41
    v_cvt_pk_bf16_f32 v204, v50, v51
    v_cvt_pk_bf16_f32 v205, v52, v53
    ds_write_b64 v4, v[204:205] offset:3168
    v_mul_f32 v58, v50, v38
    v_mul_f32 v59, v50, v39
    v_mul_f32 v60, v52, v47
    v_mul_f32 v61, v52, v48
    v_fmac_f32 v58, v51, v40
    v_fmac_f32 v59, v51, v38
    v_fmac_f32 v60, v53, v49
    v_fmac_f32 v61, v53, v47
    v_cvt_pk_bf16_f32 v214, v58, v59
    v_cvt_pk_bf16_f32 v215, v60, v61
    ds_write_b64 v4, v[214:215] offset:5808
    v_mul_f32 v54, v50, v32
    v_mul_f32 v55, v50, v33
    v_mul_f32 v56, v52, v41
    v_mul_f32 v57, v52, v42
    v_fmac_f32 v54, v51, v34
    v_fmac_f32 v55, v51, v32
    v_fmac_f32 v56, v53, v43
    v_fmac_f32 v57, v53, v41
    v_cvt_pk_bf16_f32 v206, v54, v55
    v_cvt_pk_bf16_f32 v207, v56, v57
    ds_write_b64 v4, v[206:207] offset:3696
    v_mul_f32 v62, v66, v38
    v_mul_f32 v63, v66, v39
    v_mul_f32 v64, v68, v47
    v_mul_f32 v65, v68, v48
    v_fmac_f32 v62, v67, v40
    v_fmac_f32 v63, v67, v38
    v_fmac_f32 v64, v69, v49
    v_fmac_f32 v65, v69, v47
    v_cvt_pk_bf16_f32 v218, v62, v63
    v_cvt_pk_bf16_f32 v219, v64, v65
    ds_write_b64 v4, v[218:219] offset:6864
    v_mul_f32 v66, v62, v38
    v_mul_f32 v67, v62, v39
    v_mul_f32 v68, v64, v47
    v_mul_f32 v69, v64, v48
    v_fmac_f32 v66, v63, v40
    v_fmac_f32 v67, v63, v38
    v_fmac_f32 v68, v65, v49
    v_fmac_f32 v69, v65, v47
    v_cvt_pk_bf16_f32 v222, v66, v67
    v_cvt_pk_bf16_f32 v223, v68, v69
    ds_write_b64 v4, v[222:223] offset:7920
    ds_read_b128 v[192:195], v5 offset:0
    ds_read_b128 v[196:199], v5 offset:16
    ds_read_b128 v[200:203], v5 offset:32
    ds_read_b128 v[204:207], v5 offset:48
    ds_read_b128 v[208:211], v5 offset:64
    ds_read_b128 v[212:215], v5 offset:80
    ds_read_b128 v[216:219], v5 offset:96
    ds_read_b128 v[220:223], v5 offset:112
    v_mul_f32 v74, 0x41000000, v88
    v_mul_f32 v72, 0x41000000, v89
    v_exp_f32 v74, v74
    v_fract_f32 v72, v72
    v_cos_f32 v73, v72
    v_sin_f32 v72, v72
    v_mul_f32 v35, v74, v73
    v_mul_f32 v36, v74, v72
    v_sub_f32 v37, 0, v36
    v_mul_f32 v74, 0x41000000, v90
    v_mul_f32 v72, 0x41000000, v91
    v_exp_f32 v74, v74
    v_fract_f32 v72, v72
    v_cos_f32 v73, v72
    v_sin_f32 v72, v72
    v_mul_f32 v44, v74, v73
    v_mul_f32 v45, v74, v72
    v_sub_f32 v46, 0, v45
    v_cvt_pk_bf16_f32 v128, 1.0, 0
    v_cvt_pk_bf16_f32 v129, 1.0, 0
    ds_write_b64 v4, v[128:129] offset:0
    v_cvt_pk_bf16_f32 v130, v35, v36
    v_cvt_pk_bf16_f32 v131, v44, v45
    ds_write_b64 v4, v[130:131] offset:528
    v_mov_b32 v62, v35
    v_mov_b32 v63, v36
    v_mov_b32 v64, v44
    v_mov_b32 v65, v45
    v_mul_f32 v66, v62, v35
    v_mul_f32 v67, v62, v36
    v_mul_f32 v68, v64, v44
    v_mul_f32 v69, v64, v45
    v_fmac_f32 v66, v63, v37
    v_fmac_f32 v67, v63, v35
    v_fmac_f32 v68, v65, v46
    v_fmac_f32 v69, v65, v44
    v_cvt_pk_bf16_f32 v132, v66, v67
    v_cvt_pk_bf16_f32 v133, v68, v69
    ds_write_b64 v4, v[132:133] offset:1056
    v_mul_f32 v62, v66, v35
    v_mul_f32 v63, v66, v36
    v_mul_f32 v64, v68, v44
    v_mul_f32 v65, v68, v45
    v_fmac_f32 v62, v67, v37
    v_fmac_f32 v63, v67, v35
    v_fmac_f32 v64, v69, v46
    v_fmac_f32 v65, v69, v44
    v_cvt_pk_bf16_f32 v134, v62, v63
    v_cvt_pk_bf16_f32 v135, v64, v65
    ds_write_b64 v4, v[134:135] offset:1584
    v_mul_f32 v66, v62, v35
    v_mul_f32 v67, v62, v36
    v_mul_f32 v68, v64, v44
    v_mul_f32 v69, v64, v45
    v_fmac_f32 v66, v63, v37
    v_fmac_f32 v67, v63, v35
    v_fmac_f32 v68, v65, v46
    v_fmac_f32 v69, v65, v44
    v_cvt_pk_bf16_f32 v136, v66, v67
    v_cvt_pk_bf16_f32 v137, v68, v69
    ds_write_b64 v4, v[136:137] offset:2112
    v_mul_f32 v62, v66, v35
    v_mul_f32 v63, v66, v36
    v_mul_f32 v64, v68, v44
    v_mul_f32 v65, v68, v45
    v_fmac_f32 v62, v67, v37
    v_fmac_f32 v63, v67, v35
    v_fmac_f32 v64, v69, v46
    v_fmac_f32 v65, v69, v44
    v_cvt_pk_bf16_f32 v138, v62, v63
    v_cvt_pk_bf16_f32 v139, v64, v65
    ds_write_b64 v4, v[138:139] offset:2640
    v_mul_f32 v66, v62, v35
    v_mul_f32 v67, v62, v36
    v_mul_f32 v68, v64, v44
    v_mul_f32 v69, v64, v45
    v_fmac_f32 v66, v63, v37
    v_fmac_f32 v67, v63, v35
    v_fmac_f32 v68, v65, v46
    v_fmac_f32 v69, v65, v44
    v_cvt_pk_bf16_f32 v140, v66, v67
    v_cvt_pk_bf16_f32 v141, v68, v69
    ds_write_b64 v4, v[140:141] offset:3168
    v_mul_f32 v62, v66, v35
    v_mul_f32 v63, v66, v36
    v_mul_f32 v64, v68, v44
    v_mul_f32 v65, v68, v45
    v_fmac_f32 v62, v67, v37
    v_fmac_f32 v63, v67, v35
    v_fmac_f32 v64, v69, v46
    v_fmac_f32 v65, v69, v44
    v_cvt_pk_bf16_f32 v142, v62, v63
    v_cvt_pk_bf16_f32 v143, v64, v65
    ds_write_b64 v4, v[142:143] offset:3696
    v_mul_f32 v66, v62, v35
    v_mul_f32 v67, v62, v36
    v_mul_f32 v68, v64, v44
    v_mul_f32 v69, v64, v45
    v_fmac_f32 v66, v63, v37
    v_fmac_f32 v67, v63, v35
    v_fmac_f32 v68, v65, v46
    v_fmac_f32 v69, v65, v44
    v_cvt_pk_bf16_f32 v144, v66, v67
    v_cvt_pk_bf16_f32 v145, v68, v69
    ds_write_b64 v4, v[144:145] offset:4224
    v_mul_f32 v62, v66, v35
    v_mul_f32 v63, v66, v36
    v_mul_f32 v64, v68, v44
    v_mul_f32 v65, v68, v45
    v_fmac_f32 v62, v67, v37
    v_fmac_f32 v63, v67, v35
    v_fmac_f32 v64, v69, v46
    v_fmac_f32 v65, v69, v44
    v_cvt_pk_bf16_f32 v146, v62, v63
    v_cvt_pk_bf16_f32 v147, v64, v65
    ds_write_b64 v4, v[146:147] offset:4752
    v_mul_f32 v66, v62, v35
    v_mul_f32 v67, v62, v36
    v_mul_f32 v68, v64, v44
    v_mul_f32 v69, v64, v45
    v_fmac_f32 v66, v63, v37
    v_fmac_f32 v67, v63, v35
    v_fmac_f32 v68, v65, v46
    v_fmac_f32 v69, v65, v44
    v_cvt_pk_bf16_f32 v148, v66, v67
    v_cvt_pk_bf16_f32 v149, v68, v69
    ds_write_b64 v4, v[148:149] offset:5280
    v_mul_f32 v62, v66, v35
    v_mul_f32 v63, v66, v36
    v_mul_f32 v64, v68, v44
    v_mul_f32 v65, v68, v45
    v_fmac_f32 v62, v67, v37
    v_fmac_f32 v63, v67, v35
    v_fmac_f32 v64, v69, v46
    v_fmac_f32 v65, v69, v44
    v_cvt_pk_bf16_f32 v150, v62, v63
    v_cvt_pk_bf16_f32 v151, v64, v65
    ds_write_b64 v4, v[150:151] offset:5808
    s_barrier
    v_mul_f32 v66, v62, v35
    v_mul_f32 v67, v62, v36
    v_mul_f32 v68, v64, v44
    v_mul_f32 v69, v64, v45
    v_fmac_f32 v66, v63, v37
    v_fmac_f32 v67, v63, v35
    v_fmac_f32 v68, v65, v46
    v_fmac_f32 v69, v65, v44
    v_cvt_pk_bf16_f32 v152, v66, v67
    v_cvt_pk_bf16_f32 v153, v68, v69
    v_mul_f32 v62, v66, v35
    v_mul_f32 v63, v66, v36
    v_mul_f32 v64, v68, v44
    v_mul_f32 v65, v68, v45
    v_fmac_f32 v62, v67, v37
    v_fmac_f32 v63, v67, v35
    v_fmac_f32 v64, v69, v46
    v_fmac_f32 v65, v69, v44
    v_cvt_pk_bf16_f32 v154, v62, v63
    v_cvt_pk_bf16_f32 v155, v64, v65
    v_mul_f32 v66, v62, v35
    v_mul_f32 v67, v62, v36
    v_mul_f32 v68, v64, v44
    v_mul_f32 v69, v64, v45
    v_fmac_f32 v66, v63, v37
    v_fmac_f32 v67, v63, v35
    v_fmac_f32 v68, v65, v46
    v_fmac_f32 v69, v65, v44
    v_cvt_pk_bf16_f32 v156, v66, v67
    v_cvt_pk_bf16_f32 v157, v68, v69
    v_mul_f32 v62, v66, v35
    v_mul_f32 v63, v66, v36
    v_mul_f32 v64, v68, v44
    v_mul_f32 v65, v68, v45
    v_fmac_f32 v62, v67, v37
    v_fmac_f32 v63, v67, v35
    v_fmac_f32 v64, v69, v46
    v_fmac_f32 v65, v69, v44
    v_cvt_pk_bf16_f32 v158, v62, v63
    v_cvt_pk_bf16_f32 v159, v64, v65
    v_mul_f32 v66, v62, v35
    v_mul_f32 v67, v62, v36
    v_mul_f32 v68, v64, v44
    v_mul_f32 v69, v64, v45
    v_fmac_f32 v66, v63, v37
    v_fmac_f32 v67, v63, v35
    v_fmac_f32 v68, v65, v46
    v_fmac_f32 v69, v65, v44
    v_cvt_pk_bf16_f32 v160, v66, v67
    v_cvt_pk_bf16_f32 v161, v68, v69
    v_mul_f32 v62, v66, v35
    v_mul_f32 v63, v66, v36
    v_mul_f32 v64, v68, v44
    v_mul_f32 v65, v68, v45
    v_fmac_f32 v62, v67, v37
    v_fmac_f32 v63, v67, v35
    v_fmac_f32 v64, v69, v46
    v_fmac_f32 v65, v69, v44
    v_cvt_pk_bf16_f32 v162, v62, v63
    v_cvt_pk_bf16_f32 v163, v64, v65
    v_mul_f32 v66, v62, v35
    v_mul_f32 v67, v62, v36
    v_mul_f32 v68, v64, v44
    v_mul_f32 v69, v64, v45
    v_fmac_f32 v66, v63, v37
    v_fmac_f32 v67, v63, v35
    v_fmac_f32 v68, v65, v46
    v_fmac_f32 v69, v65, v44
    v_cvt_pk_bf16_f32 v164, v66, v67
    v_cvt_pk_bf16_f32 v165, v68, v69
    v_mul_f32 v62, v66, v35
    v_mul_f32 v63, v66, v36
    v_mul_f32 v64, v68, v44
    v_mul_f32 v65, v68, v45
    v_fmac_f32 v62, v67, v37
    v_fmac_f32 v63, v67, v35
    v_fmac_f32 v64, v69, v46
    v_fmac_f32 v65, v69, v44
    v_cvt_pk_bf16_f32 v166, v62, v63
    v_cvt_pk_bf16_f32 v167, v64, v65
    v_mul_f32 v66, v62, v35
    v_mul_f32 v67, v62, v36
    v_mul_f32 v68, v64, v44
    v_mul_f32 v69, v64, v45
    v_fmac_f32 v66, v63, v37
    v_fmac_f32 v67, v63, v35
    v_fmac_f32 v68, v65, v46
    v_fmac_f32 v69, v65, v44
    v_cvt_pk_bf16_f32 v168, v66, v67
    v_cvt_pk_bf16_f32 v169, v68, v69
    v_mul_f32 v62, v66, v35
    v_mul_f32 v63, v66, v36
    v_mul_f32 v64, v68, v44
    v_mul_f32 v65, v68, v45
    v_fmac_f32 v62, v67, v37
    v_fmac_f32 v63, v67, v35
    v_fmac_f32 v64, v69, v46
    v_fmac_f32 v65, v69, v44
    v_cvt_pk_bf16_f32 v170, v62, v63
    v_cvt_pk_bf16_f32 v171, v64, v65
    s_barrier
    v_mul_f32 v66, v62, v35
    v_mul_f32 v67, v62, v36
    v_mul_f32 v68, v64, v44
    v_mul_f32 v69, v64, v45
    v_fmac_f32 v66, v63, v37
    v_fmac_f32 v67, v63, v35
    v_fmac_f32 v68, v65, v46
    v_fmac_f32 v69, v65, v44
    v_cvt_pk_bf16_f32 v172, v66, v67
    v_cvt_pk_bf16_f32 v173, v68, v69
    v_mul_f32 v62, v66, v35
    v_mul_f32 v63, v66, v36
    v_mul_f32 v64, v68, v44
    v_mul_f32 v65, v68, v45
    v_fmac_f32 v62, v67, v37
    v_fmac_f32 v63, v67, v35
    v_fmac_f32 v64, v69, v46
    v_fmac_f32 v65, v69, v44
    v_cvt_pk_bf16_f32 v174, v62, v63
    v_cvt_pk_bf16_f32 v175, v64, v65
    v_mul_f32 v66, v62, v35
    v_mul_f32 v67, v62, v36
    v_mul_f32 v68, v64, v44
    v_mul_f32 v69, v64, v45
    v_fmac_f32 v66, v63, v37
    v_fmac_f32 v67, v63, v35
    v_fmac_f32 v68, v65, v46
    v_fmac_f32 v69, v65, v44
    v_cvt_pk_bf16_f32 v176, v66, v67
    v_cvt_pk_bf16_f32 v177, v68, v69
    v_mul_f32 v62, v66, v35
    v_mul_f32 v63, v66, v36
    v_mul_f32 v64, v68, v44
    v_mul_f32 v65, v68, v45
    v_fmac_f32 v62, v67, v37
    v_fmac_f32 v63, v67, v35
    v_fmac_f32 v64, v69, v46
    v_fmac_f32 v65, v69, v44
    v_cvt_pk_bf16_f32 v178, v62, v63
    v_cvt_pk_bf16_f32 v179, v64, v65
    v_mul_f32 v66, v62, v35
    v_mul_f32 v67, v62, v36
    v_mul_f32 v68, v64, v44
    v_mul_f32 v69, v64, v45
    v_fmac_f32 v66, v63, v37
    v_fmac_f32 v67, v63, v35
    v_fmac_f32 v68, v65, v46
    v_fmac_f32 v69, v65, v44
    v_cvt_pk_bf16_f32 v180, v66, v67
    v_cvt_pk_bf16_f32 v181, v68, v69
    v_mul_f32 v62, v66, v35
    v_mul_f32 v63, v66, v36
    v_mul_f32 v64, v68, v44
    v_mul_f32 v65, v68, v45
    v_fmac_f32 v62, v67, v37
    v_fmac_f32 v63, v67, v35
    v_fmac_f32 v64, v69, v46
    v_fmac_f32 v65, v69, v44
    v_cvt_pk_bf16_f32 v182, v62, v63
    v_cvt_pk_bf16_f32 v183, v64, v65
    v_mul_f32 v66, v62, v35
    v_mul_f32 v67, v62, v36
    v_mul_f32 v68, v64, v44
    v_mul_f32 v69, v64, v45
    v_fmac_f32 v66, v63, v37
    v_fmac_f32 v67, v63, v35
    v_fmac_f32 v68, v65, v46
    v_fmac_f32 v69, v65, v44
    v_cvt_pk_bf16_f32 v184, v66, v67
    v_cvt_pk_bf16_f32 v185, v68, v69
    v_mul_f32 v62, v66, v35
    v_mul_f32 v63, v66, v36
    v_mul_f32 v64, v68, v44
    v_mul_f32 v65, v68, v45
    v_fmac_f32 v62, v67, v37
    v_fmac_f32 v63, v67, v35
    v_fmac_f32 v64, v69, v46
    v_fmac_f32 v65, v69, v44
    v_cvt_pk_bf16_f32 v186, v62, v63
    v_cvt_pk_bf16_f32 v187, v64, v65
    v_mul_f32 v66, v62, v35
    v_mul_f32 v67, v62, v36
    v_mul_f32 v68, v64, v44
    v_mul_f32 v69, v64, v45
    v_fmac_f32 v66, v63, v37
    v_fmac_f32 v67, v63, v35
    v_fmac_f32 v68, v65, v46
    v_fmac_f32 v69, v65, v44
    v_cvt_pk_bf16_f32 v188, v66, v67
    v_cvt_pk_bf16_f32 v189, v68, v69
    v_mul_f32 v62, v66, v35
    v_mul_f32 v63, v66, v36
    v_mul_f32 v64, v68, v44
    v_mul_f32 v65, v68, v45
    v_fmac_f32 v62, v67, v37
    v_fmac_f32 v63, v67, v35
    v_fmac_f32 v64, v69, v46
    v_fmac_f32 v65, v69, v44
    v_cvt_pk_bf16_f32 v190, v62, v63
    v_cvt_pk_bf16_f32 v191, v64, v65
    s_barrier
    s_barrier
    s_barrier
    ds_read_b32 v31, v1 offset:128
    s_waitcnt lgkmcnt(0)
    v_readfirstlane_b32 s6, v31
    s_lshr_b32 s15, s14, 5
    s_and_b32 s15, s15, 3
    s_lshl_b32 s15, s15, 2
    s_add_u32 s15, s15, s7
    s_lshl_b32 s15, s15, 8
    s_add_u32 s15, s15, 393216
    v_lshlrev_b32 v11, 2, v0
    buffer_load_dword v12, v11, s[64:67], s15 offen sc1
    s_lshr_b32 s10, s14, 2
    s_lshl_b32 s10, s10, 2
    s_add_u32 s10, s10, s7
    s_lshl_b32 s10, s10, 13
    s_and_b32 s9, s14, 3
    s_lshl_b32 s9, s9, 5
    s_add_u32 s10, s10, s9
    s_add_u32 s10, s10, 1048576
    v_lshrrev_b32 v13, 1, v0
    v_and_b32 v14, 1, v0
    v_lshlrev_b32 v15, 7, v13
    v_lshl_add_u32 v15, v14, 4, v15
    v_min_u32 v94, 1, v0
    v_lshlrev_b32 v94, 30, v94
    v_mov_b32 v95, s6
    s_mul_i32 s9, s12, 16896
    s_add_u32 s9, s9, 114688
    v_lshl_add_u32 v22, v0, 3, s9
    v_lshl_add_u32 v23, v0, 4, s9
    s_lshl_b32 s8, s13, 6
    s_add_u32 s8, s8, s51
    s_add_u32 s8, s8, 4224
    v_lshlrev_b32 v26, 3, v0
    v_sub_u32 v26, s8, v26
    v_lshlrev_b32 v93, 4, v0
    v_sub_u32 v27, s8, v93
    v_lshlrev_b32 v28, 5, v0
    v_sub_u32 v28, s8, v28
    v_mov_b32 v30, s8
    s_mul_i32 s50, s12, 4608
    s_add_u32 s50, s50, 148480
    v_lshl_add_u32 v16, v0, 3, s50
    v_mul_u32_u24 v17, 4608, v14
    v_lshl_add_u32 v17, v13, 4, v17
    s_lshl_b32 s8, s7, 10
    s_add_u32 s8, s8, 148992
    v_add_u32 v17, s8, v17
    v_mov_b32 v80, 0
    v_mov_b32 v81, 0
    v_mov_b32 v82, 0
    v_mov_b32 v83, 0
    v_mov_b32 v84, 0
    v_mov_b32 v85, 0
    v_mov_b32 v86, 0
    v_mov_b32 v87, 0
    v_and_b32 v18, 1, v24
    v_xor_b32 v18, 1, v18
    v_lshlrev_b32 v19, 3, v25
    v_sub_u32 v19, v19, v24
    v_add_u32 v19, v19, v18
    v_lshlrev_b32 v19, 1, v19
    v_mul_u32_u24 v18, 8512, v18
    v_add_u32 v19, v19, v18
    s_mul_i32 s8, s12, 16896
    s_lshl_b32 s9, s13, 8
    s_sub_u32 s8, s8, s9
    s_add_u32 s8, s8, 122270
    v_add_u32 v88, s8, v19
    v_subrev_u32 v89, 1024, v88
    v_subrev_u32 v90, 2048, v88
    v_subrev_u32 v91, 3072, v88
    v_lshlrev_b32 v92, 5, v24
    v_lshl_add_u32 v92, v25, 4, v92
    s_sub_u32 s8, s50, s9
    s_add_u32 s8, s8, 288
    v_add_u32 v92, s8, v92
    v_add_u32 v18, s51, v93
    s_xor_b32 s8, s7, 1
    s_mul_i32 s8, s8, 8448
    s_add_u32 s8, s8, 114688
    v_add_u32 v19, s8, v93
    s_lshl_b32 s20, s14, 1
    s_add_u32 s20, s20, s12
    s_mul_i32 s20, s20, 4352
    s_lshl_b32 s8, s13, 11
    s_add_u32 s20, s20, s8
    s_add_u32 s20, s20, 4194304
    s_lshl_b32 s19, s14, 1
    s_add_u32 s19, s19, s12
    s_lshl_b32 s19, s19, 7
    s_lshl_b32 s8, s13, 16
    s_add_u32 s19, s19, s8
    s_add_u32 s19, s19, 655360
    s_mul_i32 s23, s5, 9363
    s_lshr_b32 s23, s23, 16
    s_mul_i32 s8, s23, 7
    s_sub_u32 s24, s5, s8
    s_lshl_b32 s8, s4, 2
    s_add_u32 s23, s23, s8
    s_lshl_b32 s23, s23, 6
    s_lshl_b32 s24, s24, 6
    s_barrier
    s_waitcnt vmcnt(0)
La_7:
    v_cmp_ne_u32 vcc, s6, v12
    s_cmp_eq_u64 vcc, 0
    s_cbranch_scc0 La_7s
    buffer_load_dwordx4 v[112:115], v15, s[64:67], s10 offen offset:0 sc1
    s_add_u32 s10, s10, 2048
    buffer_load_dwordx4 v[116:119], v15, s[64:67], s10 offen offset:2048 sc1
    s_lshl_b32 s8, s12, 5
    s_add_u32 s23, s23, s8
    s_lshl_b32 s8, s13, 5
    s_add_u32 s24, s24, s8
    s_mul_i32 s25, s23, 896
    s_lshl_b32 s8, s24, 1
    s_add_u32 s25, s25, s8
    s_add_u32 s26, s25, 14336
    s_lshl_b32 s18, s23, 3
    s_add_u32 s18, s18, 16384
    s_barrier
    s_setprio 1
    ds_write_b64 v4, v[152:153] offset:6336
    ds_write_b64 v4, v[154:155] offset:6864
    ds_write_b64 v4, v[156:157] offset:7392
    ds_write_b64 v4, v[158:159] offset:7920
    ds_read_b128 v[128:131], v5 offset:0
    ds_read_b128 v[132:135], v5 offset:16
    ds_read_b128 v[136:139], v5 offset:32
    ds_read_b128 v[140:143], v5 offset:48
    ds_read_b128 v[144:147], v5 offset:64
    ds_read_b128 v[148:151], v5 offset:80
    ds_read_b128 v[152:155], v5 offset:96
    ds_read_b128 v[156:159], v5 offset:112
    ds_write_b64 v4, v[160:161] offset:0
    ds_write_b64 v4, v[162:163] offset:528
    ds_write_b64 v4, v[164:165] offset:1056
    ds_write_b64 v4, v[166:167] offset:1584
    ds_write_b64 v4, v[168:169] offset:2112
    s_waitcnt lgkmcnt(5)
    v_mfma_f32_16x16x32_bf16 v[104:107], v[224:227], v[128:131], 0
    ds_write_b64 v4, v[170:171] offset:2640
    v_mfma_f32_16x16x32_bf16 v[104:107], v[228:231], v[132:135], v[104:107]
    ds_write_b64 v4, v[172:173] offset:3168
    v_mfma_f32_16x16x32_bf16 v[104:107], v[232:235], v[136:139], v[104:107]
    ds_write_b64 v4, v[174:175] offset:3696
    v_mfma_f32_16x16x32_bf16 v[104:107], v[236:239], v[140:143], v[104:107]
    ds_write_b64 v4, v[176:177] offset:4224
    v_mfma_f32_16x16x32_bf16 v[104:107], v[240:243], v[144:147], v[104:107]
    ds_write_b64 v4, v[178:179] offset:4752
    v_mfma_f32_16x16x32_bf16 v[104:107], v[244:247], v[148:151], v[104:107]
    ds_write_b64 v4, v[180:181] offset:5280
    v_mfma_f32_16x16x32_bf16 v[104:107], v[248:251], v[152:155], v[104:107]
    ds_write_b64 v4, v[182:183] offset:5808
    v_mfma_f32_16x16x32_bf16 v[104:107], v[252:255], v[156:159], v[104:107]
    ds_write_b64 v4, v[184:185] offset:6336
    v_mfma_f32_16x16x32_bf16 v[96:99], v[192:195], v[128:131], v[96:99]
    ds_write_b64 v4, v[186:187] offset:6864
    v_mfma_f32_16x16x32_bf16 v[96:99], v[196:199], v[132:135], v[96:99]
    ds_write_b64 v4, v[188:189] offset:7392
    v_mfma_f32_16x16x32_bf16 v[96:99], v[200:203], v[136:139], v[96:99]
    ds_write_b64 v4, v[190:191] offset:7920
    v_mfma_f32_16x16x32_bf16 v[96:99], v[204:207], v[140:143], v[96:99]
    ds_read_b128 v[160:163], v5 offset:0
    ds_read_b128 v[164:167], v5 offset:16
    ds_read_b128 v[168:171], v5 offset:32
    ds_read_b128 v[172:175], v5 offset:48
    ds_read_b128 v[176:179], v5 offset:64
    ds_read_b128 v[180:183], v5 offset:80
    ds_read_b128 v[184:187], v5 offset:96
    ds_read_b128 v[188:191], v5 offset:112
    v_mfma_f32_16x16x32_bf16 v[96:99], v[208:211], v[144:147], v[96:99]
    v_mfma_f32_16x16x32_bf16 v[96:99], v[212:215], v[148:151], v[96:99]
    v_mfma_f32_16x16x32_bf16 v[96:99], v[216:219], v[152:155], v[96:99]
    v_mfma_f32_16x16x32_bf16 v[96:99], v[220:223], v[156:159], v[96:99]
    s_waitcnt lgkmcnt(7)
    v_mfma_f32_16x16x32_bf16 v[108:111], v[224:227], v[160:163], 0
    v_mfma_f32_16x16x32_bf16 v[100:103], v[192:195], v[160:163], 0
    s_waitcnt lgkmcnt(6)
    v_mfma_f32_16x16x32_bf16 v[108:111], v[228:231], v[164:167], v[108:111]
    v_mfma_f32_16x16x32_bf16 v[100:103], v[196:199], v[164:167], v[100:103]
    s_nop 1
    ds_write_b64 v6, v[96:97]
    s_waitcnt lgkmcnt(6)
    v_mfma_f32_16x16x32_bf16 v[108:111], v[232:235], v[168:171], v[108:111]
    v_mfma_f32_16x16x32_bf16 v[100:103], v[200:203], v[168:171], v[100:103]
    ds_write_b64 v7, v[98:99]
    s_waitcnt lgkmcnt(6)
    v_mfma_f32_16x16x32_bf16 v[108:111], v[236:239], v[172:175], v[108:111]
    v_mfma_f32_16x16x32_bf16 v[100:103], v[204:207], v[172:175], v[100:103]
    ds_write_b32 v8, v104 offset:2048
    s_waitcnt lgkmcnt(6)
    v_mfma_f32_16x16x32_bf16 v[108:111], v[240:243], v[176:179], v[108:111]
    v_mfma_f32_16x16x32_bf16 v[100:103], v[208:211], v[176:179], v[100:103]
    ds_write_b32 v8, v105 offset:2176
    s_waitcnt lgkmcnt(6)
    v_mfma_f32_16x16x32_bf16 v[108:111], v[244:247], v[180:183], v[108:111]
    v_mfma_f32_16x16x32_bf16 v[100:103], v[212:215], v[180:183], v[100:103]
    ds_write_b32 v8, v106 offset:2304
    s_waitcnt lgkmcnt(6)
    v_mfma_f32_16x16x32_bf16 v[108:111], v[248:251], v[184:187], v[108:111]
    v_mfma_f32_16x16x32_bf16 v[100:103], v[216:219], v[184:187], v[100:103]
    ds_write_b32 v8, v107 offset:2432
    s_waitcnt lgkmcnt(6)
    v_mfma_f32_16x16x32_bf16 v[108:111], v[252:255], v[188:191], v[108:111]
    v_mfma_f32_16x16x32_bf16 v[100:103], v[220:223], v[188:191], v[100:103]
    ds_write_b64 v16, v[80:81]
    s_nop 5
    ds_write_b32 v8, v108 offset:2112
    ds_write_b32 v8, v109 offset:2240
    ds_write_b32 v8, v110 offset:2368
    ds_write_b32 v8, v111 offset:2496
    ds_write_b64 v9, v[100:101]
    ds_write_b64 v10, v[102:103]
    ds_add_u32 v29, v2 offset:8
    s_waitcnt vmcnt(0)
    ds_write_b128 v17, v[112:115] offset:0
    ds_write_b128 v17, v[116:119] offset:512
Lw_8:
    ds_read_b32 v31, v29 offset:8
    s_waitcnt lgkmcnt(0)
    v_readfirstlane_b32 s8, v31
    s_cmp_ge_u32 s8, 2
    s_cbranch_scc0 Lw_8r
    ds_read_b128 v[32:35], v23 offset:0
    ds_read_b32 v36, v23 offset:16
    ds_read_b64 v[38:39], v22 offset:1024
    ds_read_b64 v[42:43], v22 offset:1536
    ds_read_b64 v[44:45], v22 offset:2048
    ds_read_b32 v40, v22 offset:1032
    ds_read_b32 v41, v22 offset:1544
    ds_read_b32 v46, v22 offset:2056
    ds_read_b128 v[48:51], v23 offset:8448
    ds_read_b32 v52, v23 offset:8464
    ds_read_b64 v[54:55], v22 offset:9472
    ds_read_b64 v[58:59], v22 offset:9984
    ds_read_b64 v[60:61], v22 offset:10496
    ds_read_b32 v56, v22 offset:9480
    ds_read_b32 v57, v22 offset:9992
    ds_read_b32 v62, v22 offset:10504
    s_waitcnt lgkmcnt(0)
    v_add_f32 v32, v32, v48
    v_add_f32 v33, v33, v49
    v_add_f32 v34, v34, v50
    v_add_f32 v35, v35, v51
    v_add_f32 v36, v36, v52
    v_add_f32 v38, v38, v54
    v_add_f32 v39, v39, v55
    v_add_f32 v40, v40, v56
    v_add_f32 v41, v41, v57
    v_add_f32 v42, v42, v58
    v_add_f32 v43, v43, v59
    v_add_f32 v44, v44, v60
    v_add_f32 v45, v45, v61
    v_add_f32 v46, v46, v62
    v_cvt_pk_bf16_f32 v64, v46, v46
    v_cvt_pk_bf16_f32 v67, v45, v45
    v_cvt_pk_bf16_f32 v70, v44, v44
    v_mov_b32 v65, v64
    v_mov_b32 v68, v67
    v_mov_b32 v71, v70
    v_cvt_pk_bf16_f32 v72, v41, v41
    v_cvt_pk_bf16_f32 v75, v42, v42
    s_cmp_eq_u32 s13, 1
    s_cbranch_scc1 Lodd_9
    v_mov_b32 v66, v67
    v_cvt_pk_bf16_f32 v69, v45, v44
    v_cvt_pk_bf16_f32 v73, v43, v43
    v_cvt_pk_bf16_f32 v74, v43, v42
    v_cvt_pk_bf16_f32 v76, v40, v39
    v_cvt_pk_bf16_f32 v77, v38, v38
    v_cvt_pk_bf16_f32 v78, v35, v34
    v_cvt_pk_bf16_f32 v79, v33, v32
    s_branch Ljoin_10
Lodd_9:
    v_cvt_pk_bf16_f32 v66, v46, v45
    v_mov_b32 v69, v67
    v_cvt_pk_bf16_f32 v73, v41, v43
    v_cvt_pk_bf16_f32 v74, v43, v43
    v_cvt_pk_bf16_f32 v76, v40, v40
    v_cvt_pk_bf16_f32 v77, v39, v38
    v_cvt_pk_bf16_f32 v78, v36, v35
    v_cvt_pk_bf16_f32 v79, v34, v33
    v_cvt_pk_bf16_f32 v80, v32, v81
Ljoin_10:
    ds_write_b128 v28, v[64:67] offset:2016
    ds_write_b128 v28, v[68:71] offset:2032
    ds_write_b128 v27, v[72:75] offset:3056
    ds_write_b64 v26, v[76:77] offset:3576
    ds_write_b64 v26, v[78:79] offset:4088
    s_mov_b64 exec, 1
    ds_write_b128 v30, v[80:83] offset:4096
    ds_write_b128 v30, v[84:87] offset:4112
    s_mov_b64 exec, -1
    v_mov_b32 v28, v93
    ds_add_u32 v1, v2 offset:16
    v_mov_b32 v32, s101
    v_mov_b32 v33, s101
    v_mov_b32 v34, s101
    v_mov_b32 v35, s101
Lw_11:
    ds_read_b32 v31, v1 offset:16
    s_waitcnt lgkmcnt(0)
    v_readfirstlane_b32 s8, v31
    s_cmp_ge_u32 s8, 4
    s_cbranch_scc0 Lw_11r
    s_setprio 1
    ds_read2_b32 v[128:129], v88 offset0:176 offset1:177
    ds_read2_b32 v[130:131], v88 offset0:178 offset1:179
    ds_read_b128 v[160:163], v92 offset:192
    ds_read2_b32 v[132:133], v88 offset0:48 offset1:49
    ds_read2_b32 v[134:135], v88 offset0:50 offset1:51
    ds_read_b128 v[164:167], v92 offset:704
    ds_read2_b32 v[136:137], v89 offset0:176 offset1:177
    ds_read2_b32 v[138:139], v89 offset0:178 offset1:179
    ds_read_b128 v[168:171], v92 offset:1216
    ds_read2_b32 v[140:141], v89 offset0:48 offset1:49
    ds_read2_b32 v[142:143], v89 offset0:50 offset1:51
    ds_read_b128 v[172:175], v92 offset:1728
    ds_read2_b32 v[144:145], v90 offset0:176 offset1:177
    ds_read2_b32 v[146:147], v90 offset0:178 offset1:179
    ds_read_b128 v[176:179], v92 offset:2240
    ds_read2_b32 v[148:149], v90 offset0:48 offset1:49
    ds_read2_b32 v[150:151], v90 offset0:50 offset1:51
    ds_read_b128 v[180:183], v92 offset:2752
    ds_read2_b32 v[152:153], v91 offset0:176 offset1:177
    ds_read2_b32 v[154:155], v91 offset0:178 offset1:179
    ds_read_b128 v[184:187], v92 offset:3264
    ds_read2_b32 v[156:157], v91 offset0:48 offset1:49
    ds_read2_b32 v[158:159], v91 offset0:50 offset1:51
    ds_read_b128 v[188:191], v92 offset:3776
    s_waitcnt lgkmcnt(15)
    v_mfma_f32_16x16x32_bf16 v[96:99], v[128:131], v[160:163], v[32:35]
    v_mfma_f32_16x16x32_bf16 v[100:103], v[132:135], v[160:163], v[32:35]
    v_mfma_f32_16x16x32_bf16 v[104:107], v[132:135], v[164:167], v[32:35]
    v_mfma_f32_16x16x32_bf16 v[100:103], v[128:131], v[164:167], v[100:103]
    v_mfma_f32_16x16x32_bf16 v[104:107], v[136:139], v[160:163], v[104:107]
    v_mfma_f32_16x16x32_bf16 v[108:111], v[136:139], v[164:167], v[32:35]
    v_mfma_f32_16x16x32_bf16 v[112:115], v[136:139], v[168:171], v[32:35]
    v_mfma_f32_16x16x32_bf16 v[104:107], v[128:131], v[168:171], v[104:107]
    v_mfma_f32_16x16x32_bf16 v[108:111], v[132:135], v[168:171], v[108:111]
    s_waitcnt lgkmcnt(13)
    s_waitcnt lgkmcnt(12)
    v_mfma_f32_16x16x32_bf16 v[108:111], v[140:143], v[160:163], v[108:111]
    v_mfma_f32_16x16x32_bf16 v[112:115], v[140:143], v[164:167], v[112:115]
    v_mfma_f32_16x16x32_bf16 v[116:119], v[140:143], v[168:171], v[32:35]
    v_mfma_f32_16x16x32_bf16 v[120:123], v[140:143], v[172:175], v[32:35]
    v_mfma_f32_16x16x32_bf16 v[108:111], v[128:131], v[172:175], v[108:111]
    ds_read2_b32 v[192:193], v88 offset0:160 offset1:161
    ds_read2_b32 v[194:195], v88 offset0:162 offset1:163
    v_mfma_f32_16x16x32_bf16 v[112:115], v[132:135], v[172:175], v[112:115]
    ds_read_b128 v[224:227], v92 offset:128
    v_mfma_f32_16x16x32_bf16 v[116:119], v[136:139], v[172:175], v[116:119]
    ds_read2_b32 v[196:197], v88 offset0:32 offset1:33
    ds_read2_b32 v[198:199], v88 offset0:34 offset1:35
    s_waitcnt lgkmcnt(15)
    s_waitcnt lgkmcnt(14)
    v_mfma_f32_16x16x32_bf16 v[112:115], v[144:147], v[160:163], v[112:115]
    ds_read_b128 v[228:231], v92 offset:640
    v_mfma_f32_16x16x32_bf16 v[116:119], v[144:147], v[164:167], v[116:119]
    ds_read2_b32 v[200:201], v89 offset0:160 offset1:161
    ds_read2_b32 v[202:203], v89 offset0:162 offset1:163
    v_mfma_f32_16x16x32_bf16 v[120:123], v[144:147], v[168:171], v[120:123]
    ds_read_b128 v[232:235], v92 offset:1152
    v_mfma_f32_16x16x32_bf16 v[124:127], v[144:147], v[172:175], v[32:35]
    ds_read2_b32 v[204:205], v89 offset0:32 offset1:33
    ds_read2_b32 v[206:207], v89 offset0:34 offset1:35
    v_mfma_f32_16x16x32_bf16 v[112:115], v[128:131], v[176:179], v[112:115]
    ds_read_b128 v[236:239], v92 offset:1664
    v_mfma_f32_16x16x32_bf16 v[116:119], v[132:135], v[176:179], v[116:119]
    ds_read2_b32 v[208:209], v90 offset0:160 offset1:161
    ds_read2_b32 v[210:211], v90 offset0:162 offset1:163
    v_mfma_f32_16x16x32_bf16 v[120:123], v[136:139], v[176:179], v[120:123]
    ds_read_b128 v[240:243], v92 offset:2176
    v_mfma_f32_16x16x32_bf16 v[124:127], v[140:143], v[176:179], v[124:127]
    ds_read2_b32 v[212:213], v90 offset0:32 offset1:33
    ds_read2_b32 v[214:215], v90 offset0:34 offset1:35
    s_waitcnt lgkmcnt(15)
    v_mfma_f32_16x16x32_bf16 v[116:119], v[148:151], v[160:163], v[116:119]
    ds_read_b128 v[244:247], v92 offset:2688
    v_mfma_f32_16x16x32_bf16 v[120:123], v[148:151], v[164:167], v[120:123]
    ds_read2_b32 v[216:217], v91 offset0:160 offset1:161
    ds_read2_b32 v[218:219], v91 offset0:162 offset1:163
    v_mfma_f32_16x16x32_bf16 v[124:127], v[148:151], v[168:171], v[124:127]
    ds_read_b128 v[248:251], v92 offset:3200
    v_mfma_f32_16x16x32_bf16 v[116:119], v[128:131], v[180:183], v[116:119]
    ds_read2_b32 v[220:221], v91 offset0:32 offset1:33
    ds_read2_b32 v[222:223], v91 offset0:34 offset1:35
    v_mfma_f32_16x16x32_bf16 v[120:123], v[132:135], v[180:183], v[120:123]
    ds_read_b128 v[252:255], v92 offset:3712
    v_mfma_f32_16x16x32_bf16 v[124:127], v[136:139], v[180:183], v[124:127]
    v_mfma_f32_16x16x32_bf16 v[120:123], v[152:155], v[160:163], v[120:123]
    v_mfma_f32_16x16x32_bf16 v[124:127], v[152:155], v[164:167], v[124:127]
    v_mfma_f32_16x16x32_bf16 v[120:123], v[128:131], v[184:187], v[120:123]
    v_mfma_f32_16x16x32_bf16 v[124:127], v[132:135], v[184:187], v[124:127]
    v_mfma_f32_16x16x32_bf16 v[124:127], v[156:159], v[160:163], v[124:127]
    v_mfma_f32_16x16x32_bf16 v[124:127], v[128:131], v[188:191], v[124:127]
    s_waitcnt lgkmcnt(15)
    v_mfma_f32_16x16x32_bf16 v[96:99], v[192:195], v[224:227], v[96:99]
    v_mfma_f32_16x16x32_bf16 v[100:103], v[196:199], v[224:227], v[100:103]
    ds_read2_b32 v[128:129], v88 offset0:144 offset1:145
    ds_read2_b32 v[130:131], v88 offset0:146 offset1:147
    v_mfma_f32_16x16x32_bf16 v[104:107], v[196:199], v[228:231], v[104:107]
    ds_read_b128 v[160:163], v92 offset:64
    v_mfma_f32_16x16x32_bf16 v[100:103], v[192:195], v[228:231], v[100:103]
    ds_read2_b32 v[132:133], v88 offset0:16 offset1:17
    ds_read2_b32 v[134:135], v88 offset0:18 offset1:19
    v_mfma_f32_16x16x32_bf16 v[104:107], v[200:203], v[224:227], v[104:107]
    ds_read_b128 v[164:167], v92 offset:576
    v_mfma_f32_16x16x32_bf16 v[108:111], v[200:203], v[228:231], v[108:111]
    v_lshrrev_b32 v26, 2, v0
    v_mul_u32_u24 v26, 896, v26
    ds_read2_b32 v[136:137], v89 offset0:144 offset1:145
    ds_read2_b32 v[138:139], v89 offset0:146 offset1:147
    v_mfma_f32_16x16x32_bf16 v[112:115], v[200:203], v[232:235], v[112:115]
    ds_read_b128 v[168:171], v92 offset:1088
    v_mfma_f32_16x16x32_bf16 v[104:107], v[192:195], v[232:235], v[104:107]
    ds_read2_b32 v[140:141], v89 offset0:16 offset1:17
    ds_read2_b32 v[142:143], v89 offset0:18 offset1:19
    v_mfma_f32_16x16x32_bf16 v[108:111], v[196:199], v[232:235], v[108:111]
    ds_read_b128 v[172:175], v92 offset:1600
    s_waitcnt lgkmcnt(15)
    v_mfma_f32_16x16x32_bf16 v[108:111], v[204:207], v[224:227], v[108:111]
    ds_read2_b32 v[144:145], v90 offset0:144 offset1:145
    ds_read2_b32 v[146:147], v90 offset0:146 offset1:147
    v_mfma_f32_16x16x32_bf16 v[112:115], v[204:207], v[228:231], v[112:115]
    ds_read_b128 v[176:179], v92 offset:2112
    v_mfma_f32_16x16x32_bf16 v[116:119], v[204:207], v[232:235], v[116:119]
    v_and_b32 v27, 3, v0
    v_lshl_add_u32 v26, v27, 4, v26
    ds_read2_b32 v[148:149], v90 offset0:16 offset1:17
    ds_read2_b32 v[150:151], v90 offset0:18 offset1:19
    v_mfma_f32_16x16x32_bf16 v[120:123], v[204:207], v[236:239], v[120:123]
    ds_read_b128 v[180:183], v92 offset:2624
    v_mfma_f32_16x16x32_bf16 v[108:111], v[192:195], v[236:239], v[108:111]
    ds_read2_b32 v[152:153], v91 offset0:144 offset1:145
    ds_read2_b32 v[154:155], v91 offset0:146 offset1:147
    v_mfma_f32_16x16x32_bf16 v[112:115], v[196:199], v[236:239], v[112:115]
    ds_read_b128 v[184:187], v92 offset:3136
    v_mfma_f32_16x16x32_bf16 v[116:119], v[200:203], v[236:239], v[116:119]
    ds_read2_b32 v[156:157], v91 offset0:16 offset1:17
    ds_read2_b32 v[158:159], v91 offset0:18 offset1:19
    v_mfma_f32_16x16x32_bf16 v[112:115], v[208:211], v[224:227], v[112:115]
    ds_read_b128 v[188:191], v92 offset:3648
    v_mfma_f32_16x16x32_bf16 v[116:119], v[208:211], v[228:231], v[116:119]
    v_and_b32 v36, 31, v0
    v_lshlrev_b32 v56, 3, v36
    v_mfma_f32_16x16x32_bf16 v[120:123], v[208:211], v[232:235], v[120:123]
    v_mfma_f32_16x16x32_bf16 v[124:127], v[208:211], v[236:239], v[124:127]
    v_mfma_f32_16x16x32_bf16 v[112:115], v[192:195], v[240:243], v[112:115]
    v_mfma_f32_16x16x32_bf16 v[116:119], v[196:199], v[240:243], v[116:119]
    v_mfma_f32_16x16x32_bf16 v[120:123], v[200:203], v[240:243], v[120:123]
    v_mfma_f32_16x16x32_bf16 v[124:127], v[204:207], v[240:243], v[124:127]
    buffer_load_dwordx4 v[64:67], v26, s[52:55], s25 offen
    v_mfma_f32_16x16x32_bf16 v[116:119], v[212:215], v[224:227], v[116:119]
    v_mfma_f32_16x16x32_bf16 v[120:123], v[212:215], v[228:231], v[120:123]
    v_mfma_f32_16x16x32_bf16 v[124:127], v[212:215], v[232:235], v[124:127]
    v_mfma_f32_16x16x32_bf16 v[116:119], v[192:195], v[244:247], v[116:119]
    v_mfma_f32_16x16x32_bf16 v[120:123], v[196:199], v[244:247], v[120:123]
    v_mfma_f32_16x16x32_bf16 v[124:127], v[200:203], v[244:247], v[124:127]
    buffer_load_dwordx4 v[68:71], v26, s[52:55], s26 offen
    v_mfma_f32_16x16x32_bf16 v[120:123], v[216:219], v[224:227], v[120:123]
    v_mfma_f32_16x16x32_bf16 v[124:127], v[216:219], v[228:231], v[124:127]
    v_mfma_f32_16x16x32_bf16 v[120:123], v[192:195], v[248:251], v[120:123]
    v_mfma_f32_16x16x32_bf16 v[124:127], v[196:199], v[248:251], v[124:127]
    s_waitcnt lgkmcnt(15)
    v_mfma_f32_16x16x32_bf16 v[124:127], v[220:223], v[224:227], v[124:127]
    v_mfma_f32_16x16x32_bf16 v[124:127], v[192:195], v[252:255], v[124:127]
    buffer_load_dwordx2 v[80:81], v56, s[64:67], s18 offen sc1
    v_mfma_f32_16x16x32_bf16 v[96:99], v[128:131], v[160:163], v[96:99]
    v_mfma_f32_16x16x32_bf16 v[100:103], v[132:135], v[160:163], v[100:103]
    ds_read2_b32 v[192:193], v88 offset0:128 offset1:129
    ds_read2_b32 v[194:195], v88 offset0:130 offset1:131
    v_mfma_f32_16x16x32_bf16 v[104:107], v[132:135], v[164:167], v[104:107]
    ds_read_b128 v[224:227], v92 offset:0
    v_mfma_f32_16x16x32_bf16 v[100:103], v[128:131], v[164:167], v[100:103]
    ds_read2_b32 v[196:197], v88 offset0:0 offset1:1
    ds_read2_b32 v[198:199], v88 offset0:2 offset1:3
    v_mfma_f32_16x16x32_bf16 v[104:107], v[136:139], v[160:163], v[104:107]
    ds_read_b128 v[228:231], v92 offset:512
    v_mfma_f32_16x16x32_bf16 v[108:111], v[136:139], v[164:167], v[108:111]
    ds_read2_b32 v[200:201], v89 offset0:128 offset1:129
    ds_read2_b32 v[202:203], v89 offset0:130 offset1:131
    v_mfma_f32_16x16x32_bf16 v[112:115], v[136:139], v[168:171], v[112:115]
    ds_read_b128 v[232:235], v92 offset:1024
    v_mfma_f32_16x16x32_bf16 v[104:107], v[128:131], v[168:171], v[104:107]
    ds_read2_b32 v[204:205], v89 offset0:0 offset1:1
    ds_read2_b32 v[206:207], v89 offset0:2 offset1:3
    v_mfma_f32_16x16x32_bf16 v[108:111], v[132:135], v[168:171], v[108:111]
    ds_read_b128 v[236:239], v92 offset:1536
    s_waitcnt lgkmcnt(15)
    v_mfma_f32_16x16x32_bf16 v[108:111], v[140:143], v[160:163], v[108:111]
    ds_read2_b32 v[208:209], v90 offset0:128 offset1:129
    ds_read2_b32 v[210:211], v90 offset0:130 offset1:131
    v_mfma_f32_16x16x32_bf16 v[112:115], v[140:143], v[164:167], v[112:115]
    ds_read_b128 v[240:243], v92 offset:2048
    v_mfma_f32_16x16x32_bf16 v[116:119], v[140:143], v[168:171], v[116:119]
    ds_read2_b32 v[212:213], v90 offset0:0 offset1:1
    ds_read2_b32 v[214:215], v90 offset0:2 offset1:3
    v_mfma_f32_16x16x32_bf16 v[120:123], v[140:143], v[172:175], v[120:123]
    ds_read_b128 v[244:247], v92 offset:2560
    v_mfma_f32_16x16x32_bf16 v[108:111], v[128:131], v[172:175], v[108:111]
    ds_read2_b32 v[216:217], v91 offset0:128 offset1:129
    ds_read2_b32 v[218:219], v91 offset0:130 offset1:131
    v_mfma_f32_16x16x32_bf16 v[112:115], v[132:135], v[172:175], v[112:115]
    ds_read_b128 v[248:251], v92 offset:3072
    v_mfma_f32_16x16x32_bf16 v[116:119], v[136:139], v[172:175], v[116:119]
    ds_read2_b32 v[220:221], v91 offset0:0 offset1:1
    ds_read2_b32 v[222:223], v91 offset0:2 offset1:3
    v_mfma_f32_16x16x32_bf16 v[112:115], v[144:147], v[160:163], v[112:115]
    ds_read_b128 v[252:255], v92 offset:3584
    v_mfma_f32_16x16x32_bf16 v[116:119], v[144:147], v[164:167], v[116:119]
    v_mfma_f32_16x16x32_bf16 v[120:123], v[144:147], v[168:171], v[120:123]
    v_mfma_f32_16x16x32_bf16 v[124:127], v[144:147], v[172:175], v[124:127]
    v_mfma_f32_16x16x32_bf16 v[112:115], v[128:131], v[176:179], v[112:115]
    v_mfma_f32_16x16x32_bf16 v[116:119], v[132:135], v[176:179], v[116:119]
    v_mfma_f32_16x16x32_bf16 v[120:123], v[136:139], v[176:179], v[120:123]
    v_mfma_f32_16x16x32_bf16 v[124:127], v[140:143], v[176:179], v[124:127]
    v_mfma_f32_16x16x32_bf16 v[116:119], v[148:151], v[160:163], v[116:119]
    v_mfma_f32_16x16x32_bf16 v[120:123], v[148:151], v[164:167], v[120:123]
    v_mfma_f32_16x16x32_bf16 v[124:127], v[148:151], v[168:171], v[124:127]
    v_mfma_f32_16x16x32_bf16 v[116:119], v[128:131], v[180:183], v[116:119]
    v_mfma_f32_16x16x32_bf16 v[120:123], v[132:135], v[180:183], v[120:123]
    v_mfma_f32_16x16x32_bf16 v[124:127], v[136:139], v[180:183], v[124:127]
    v_mfma_f32_16x16x32_bf16 v[120:123], v[152:155], v[160:163], v[120:123]
    v_mfma_f32_16x16x32_bf16 v[124:127], v[152:155], v[164:167], v[124:127]
    v_mfma_f32_16x16x32_bf16 v[120:123], v[128:131], v[184:187], v[120:123]
    v_mfma_f32_16x16x32_bf16 v[124:127], v[132:135], v[184:187], v[124:127]
    s_waitcnt lgkmcnt(15)
    v_mfma_f32_16x16x32_bf16 v[124:127], v[156:159], v[160:163], v[124:127]
    v_mfma_f32_16x16x32_bf16 v[124:127], v[128:131], v[188:191], v[124:127]
    v_mfma_f32_16x16x32_bf16 v[96:99], v[192:195], v[224:227], v[96:99]
    v_mfma_f32_16x16x32_bf16 v[100:103], v[196:199], v[224:227], v[100:103]
    v_mfma_f32_16x16x32_bf16 v[104:107], v[196:199], v[228:231], v[104:107]
    v_mfma_f32_16x16x32_bf16 v[100:103], v[192:195], v[228:231], v[100:103]
    v_mfma_f32_16x16x32_bf16 v[104:107], v[200:203], v[224:227], v[104:107]
    v_mfma_f32_16x16x32_bf16 v[108:111], v[200:203], v[228:231], v[108:111]
    v_mfma_f32_16x16x32_bf16 v[112:115], v[200:203], v[232:235], v[112:115]
    v_mfma_f32_16x16x32_bf16 v[104:107], v[192:195], v[232:235], v[104:107]
    v_mfma_f32_16x16x32_bf16 v[108:111], v[196:199], v[232:235], v[108:111]
    s_waitcnt lgkmcnt(13)
    s_waitcnt lgkmcnt(12)
    v_mfma_f32_16x16x32_bf16 v[108:111], v[204:207], v[224:227], v[108:111]
    v_mfma_f32_16x16x32_bf16 v[112:115], v[204:207], v[228:231], v[112:115]
    v_mfma_f32_16x16x32_bf16 v[116:119], v[204:207], v[232:235], v[116:119]
    v_mfma_f32_16x16x32_bf16 v[120:123], v[204:207], v[236:239], v[120:123]
    v_mfma_f32_16x16x32_bf16 v[108:111], v[192:195], v[236:239], v[108:111]
    v_mfma_f32_16x16x32_bf16 v[112:115], v[196:199], v[236:239], v[112:115]
    v_mfma_f32_16x16x32_bf16 v[116:119], v[200:203], v[236:239], v[116:119]
    s_waitcnt lgkmcnt(10)
    s_waitcnt lgkmcnt(9)
    v_mfma_f32_16x16x32_bf16 v[112:115], v[208:211], v[224:227], v[112:115]
    v_mfma_f32_16x16x32_bf16 v[116:119], v[208:211], v[228:231], v[116:119]
    v_mfma_f32_16x16x32_bf16 v[120:123], v[208:211], v[232:235], v[120:123]
    v_mfma_f32_16x16x32_bf16 v[124:127], v[208:211], v[236:239], v[124:127]
    v_mfma_f32_16x16x32_bf16 v[112:115], v[192:195], v[240:243], v[112:115]
    v_mfma_f32_16x16x32_bf16 v[116:119], v[196:199], v[240:243], v[116:119]
    v_mfma_f32_16x16x32_bf16 v[120:123], v[200:203], v[240:243], v[120:123]
    v_mfma_f32_16x16x32_bf16 v[124:127], v[204:207], v[240:243], v[124:127]
    s_waitcnt lgkmcnt(7)
    s_waitcnt lgkmcnt(6)
    v_mfma_f32_16x16x32_bf16 v[116:119], v[212:215], v[224:227], v[116:119]
    v_mfma_f32_16x16x32_bf16 v[120:123], v[212:215], v[228:231], v[120:123]
    v_mfma_f32_16x16x32_bf16 v[124:127], v[212:215], v[232:235], v[124:127]
    v_mfma_f32_16x16x32_bf16 v[116:119], v[192:195], v[244:247], v[116:119]
    v_mfma_f32_16x16x32_bf16 v[120:123], v[196:199], v[244:247], v[120:123]
    v_mfma_f32_16x16x32_bf16 v[124:127], v[200:203], v[244:247], v[124:127]
    s_waitcnt lgkmcnt(4)
    s_waitcnt lgkmcnt(3)
    v_mfma_f32_16x16x32_bf16 v[120:123], v[216:219], v[224:227], v[120:123]
    v_mfma_f32_16x16x32_bf16 v[124:127], v[216:219], v[228:231], v[124:127]
    v_mfma_f32_16x16x32_bf16 v[120:123], v[192:195], v[248:251], v[120:123]
    v_mfma_f32_16x16x32_bf16 v[124:127], v[196:199], v[248:251], v[124:127]
    s_waitcnt lgkmcnt(1)
    s_waitcnt lgkmcnt(0)
    v_mfma_f32_16x16x32_bf16 v[124:127], v[220:223], v[224:227], v[124:127]
    v_mfma_f32_16x16x32_bf16 v[124:127], v[192:195], v[252:255], v[124:127]
    s_cmp_eq_u32 s13, 1
    s_nop 7
    s_cbranch_scc1 Lh_12
    ds_write_b128 v18, v[112:115] offset:0
    ds_write_b128 v18, v[116:119] offset:1024
    ds_write_b128 v18, v[120:123] offset:2048
    ds_write_b128 v18, v[124:127] offset:3072
    s_branch Lk_13
Lh_12:
    ds_write_b128 v18, v[96:99] offset:0
    ds_write_b128 v18, v[100:103] offset:1024
    ds_write_b128 v18, v[104:107] offset:2048
    ds_write_b128 v18, v[108:111] offset:3072
    v_mov_b32 v96, v112
    v_mov_b32 v97, v113
    v_mov_b32 v98, v114
    v_mov_b32 v99, v115
    v_mov_b32 v100, v116
    v_mov_b32 v101, v117
    v_mov_b32 v102, v118
    v_mov_b32 v103, v119
    v_mov_b32 v104, v120
    v_mov_b32 v105, v121
    v_mov_b32 v106, v122
    v_mov_b32 v107, v123
    v_mov_b32 v108, v124
    v_mov_b32 v109, v125
    v_mov_b32 v110, v126
    v_mov_b32 v111, v127
Lk_13:
    ds_add_u32 v29, v2 offset:24
Lw_14:
    ds_read_b32 v31, v29 offset:24
    s_waitcnt lgkmcnt(0)
    v_readfirstlane_b32 s8, v31
    s_cmp_ge_u32 s8, 2
    s_cbranch_scc0 Lw_14r
    ds_read_b128 v[128:131], v19 offset:0
    ds_read_b128 v[132:135], v19 offset:1024
    ds_read_b128 v[136:139], v19 offset:2048
    ds_read_b128 v[140:143], v19 offset:3072
    s_waitcnt lgkmcnt(3)
    v_add_f32 v96, v96, v128
    v_add_f32 v97, v97, v129
    v_add_f32 v98, v98, v130
    v_add_f32 v99, v99, v131
    v_cvt_pk_bf16_f32 v144, v96, v97
    v_cvt_pk_bf16_f32 v145, v98, v99
    s_waitcnt lgkmcnt(2)
    v_add_f32 v100, v100, v132
    v_add_f32 v101, v101, v133
    v_add_f32 v102, v102, v134
    v_add_f32 v103, v103, v135
    v_cvt_pk_bf16_f32 v146, v100, v101
    v_cvt_pk_bf16_f32 v147, v102, v103
    s_nop 0
    v_permlane16_swap_b32 v144, v146
    v_permlane16_swap_b32 v145, v147
    buffer_store_dwordx4 v[144:147], v28, s[64:67], s20 offen offset:0 sc1
    s_waitcnt lgkmcnt(1)
    v_add_f32 v104, v104, v136
    v_add_f32 v105, v105, v137
    v_add_f32 v106, v106, v138
    v_add_f32 v107, v107, v139
    v_cvt_pk_bf16_f32 v148, v104, v105
    v_cvt_pk_bf16_f32 v149, v106, v107
    s_waitcnt lgkmcnt(0)
    v_add_f32 v108, v108, v140
    v_add_f32 v109, v109, v141
    v_add_f32 v110, v110, v142
    v_add_f32 v111, v111, v143
    v_cvt_pk_bf16_f32 v150, v108, v109
    v_cvt_pk_bf16_f32 v151, v110, v111
    s_nop 0
    v_permlane16_swap_b32 v148, v150
    v_permlane16_swap_b32 v149, v151
    buffer_store_dwordx4 v[148:151], v28, s[64:67], s20 offen offset:1024 sc1
    v_and_b32 v38, 3, v0
    v_bfe_u32 v34, v0, 2, 2
    v_lshrrev_b32 v40, 3, v0
    v_and_b32 v41, 1, v34
    v_mul_u32_u24 v33, 4352, v40
    v_lshl_add_u32 v33, v41, 9, v33
    v_lshl_add_u32 v33, v38, 4, v33
    s_and_b32 s14, s24, 65472
    s_lshl_b32 s9, s7, 4
    s_add_u32 s14, s14, s9
    s_lshl_b32 s16, s14, 7
    s_lshr_b32 s9, s23, 10
    s_lshl_b32 s9, s9, 16
    s_add_u32 s16, s16, s9
    s_add_u32 s16, s16, 655360
    v_lshlrev_b32 v60, 7, v24
    s_mul_i32 s14, s14, 4352
    s_lshr_b32 s9, s23, 9
    s_lshl_b32 s9, s9, 10
    s_add_u32 s14, s14, s9
    s_and_b32 s9, s23, 256
    s_lshl_b32 s9, s9, 0
    s_add_u32 s14, s14, s9
    s_and_b32 s9, s23, 192
    s_lshl_b32 s9, s9, 0
    s_add_u32 s14, s14, s9
    s_add_u32 s14, s14, 4194304
    s_add_u32 s15, s14, 34816
    s_add_u32 s9, s51, 4224
    v_add_u32 v30, s9, v28
    s_waitcnt vmcnt(3)
    ds_write_b128 v30, v[64:67]
    ds_write_b128 v30, v[68:71] offset:1024
    v_lshlrev_b32 v36, 6, v36
    v_lshrrev_b32 v39, 5, v0
    v_lshl_add_u32 v36, v39, 3, v36
    v_add_u32 v36, s9, v36
    ds_read_b64 v[64:65], v36 offset:0
    ds_read_b64 v[66:67], v36 offset:16
    ds_read_b64 v[68:69], v36 offset:32
    ds_read_b64 v[70:71], v36 offset:48
    v_lshlrev_b32 v35, 5, v38
    v_lshl_add_u32 v35, v41, 4, v35
    v_and_b32 v37, 1, v25
    v_lshlrev_b32 v37, 6, v37
    v_xor_b32 v35, v35, v37
    v_lshl_add_u32 v35, v40, 7, v35
    s_lshl_b32 s9, s7, 11
    s_add_u32 s9, s9, 148480
    v_add_u32 v35, s9, v35
    v_lshrrev_b32 v37, 1, v34
    v_xor_b32 v37, s12, v37
    v_lshlrev_b32 v36, 6, v37
    v_and_b32 v37, 1, v25
    v_lshl_add_u32 v36, v37, 5, v36
    v_lshl_add_u32 v36, v38, 3, v36
    v_lshl_add_u32 v37, v39, 2, v34
    v_lshl_add_u32 v36, v37, 7, v36
    s_lshl_b32 s9, s13, 12
    s_add_u32 s9, s9, 148480
    v_add_u32 v36, s9, v36
    s_waitcnt lgkmcnt(0)
    v_lshlrev_b32 v96, 16, v64
    v_and_b32 v97, 0xffff0000, v64
    v_lshlrev_b32 v98, 16, v65
    v_and_b32 v99, 0xffff0000, v65
    ds_write_b128 v30, v[96:99] offset:0
    v_lshlrev_b32 v100, 16, v66
    v_and_b32 v101, 0xffff0000, v66
    v_lshlrev_b32 v102, 16, v67
    v_and_b32 v103, 0xffff0000, v67
    ds_write_b128 v30, v[100:103] offset:1024
    v_lshlrev_b32 v104, 16, v68
    v_and_b32 v105, 0xffff0000, v68
    v_lshlrev_b32 v106, 16, v69
    v_and_b32 v107, 0xffff0000, v69
    ds_write_b128 v30, v[104:107] offset:2048
    v_lshlrev_b32 v108, 16, v70
    v_and_b32 v109, 0xffff0000, v70
    v_lshlrev_b32 v110, 16, v71
    v_and_b32 v111, 0xffff0000, v71
    ds_write_b128 v30, v[108:111] offset:3072
    s_lshl_b32 s8, s7, 2
    v_add_u32 v31, s8, v1
    v_xor_b32 v29, 4, v29
    s_lshl_b32 s9, s7, 8
    s_add_u32 s9, s9, 159360
    v_lshl_add_u32 v57, v0, 2, s9
    v_lshrrev_b32 v94, 5, v0
    v_lshlrev_b32 v94, 30, v94
    v_lshl_add_u32 v94, v0, 2, v94
    s_waitcnt vmcnt(0)
    buffer_store_dword v95, v94, s[64:67], s19 offen sc1
    s_setprio 0
Lw_15:
    ds_read_b32 v32, v29 offset:24
    s_waitcnt lgkmcnt(0)
    v_readfirstlane_b32 s8, v32
    s_cmp_ge_u32 s8, 2
    s_cbranch_scc0 Lw_15r
La_16:
    v_cmp_ne_u32 vcc, s6, v81
    s_cmp_eq_u64 vcc, 0
    s_cbranch_scc0 La_16s
    v_and_b32 v80, 0xffff0000, v80
    v_rcp_f32 v80, v80
    s_nop 0
    v_mul_f32 v80, v80, v80
    ds_write_b32 v57, v80
Lw_17:
    ds_read_b32 v32, v31 offset:104
    s_waitcnt lgkmcnt(0)
    v_readfirstlane_b32 s8, v32
    s_cmp_ge_u32 s8, 1
    s_cbranch_scc0 Lw_17r
    s_setprio 3
Lp_18:
    buffer_load_dword v32, v60, s[64:67], s16 offen sc1
    s_waitcnt vmcnt(0)
    v_cmp_ne_u32 vcc, s6, v32
    s_cmp_eq_u64 vcc, 0
    s_cbranch_scc0 Lp_18r
    buffer_load_dwordx4 v[112:115], v33, s[64:67], s14 offen sc1
    buffer_load_dwordx4 v[116:119], v33, s[64:67], s15 offen sc1
    s_waitcnt vmcnt(1)
    ds_write_b128 v35, v[112:115] offset:0
    s_waitcnt vmcnt(0)
    ds_write_b128 v35, v[116:119] offset:1024
    s_waitcnt lgkmcnt(0)
    s_barrier
    s_endpgm
L_SH:
    s_lshr_b32 s10, s4, 1
    s_lshl_b32 s10, s10, 2
    s_add_u32 s10, s10, s5
    s_sub_u32 s10, s10, 28
    s_min_u32 s10, s10, 13
    s_and_b32 s11, s4, 1
    s_mul_i32 s11, s11, 14
    s_add_u32 s11, s11, s10
    s_mul_i32 s12, s7, 401408
    s_lshl_b32 s8, s11, 7
    s_add_u32 s12, s12, s8
    v_lshrrev_b32 v16, 3, v0
    v_and_b32 v17, 7, v0
    v_mul_u32_u24 v3, 3584, v16
    v_lshl_add_u32 v3, v17, 4, v3
    v_mov_b32 v26, 0x00003f80
    v_mov_b32 v27, 0x3f800000
    s_waitcnt lgkmcnt(0)
    s_mov_b32 s56, s36
    s_and_b32 s57, s37, 0xffff
    s_mov_b32 s58, 1605632
    s_mov_b32 s59, 0x20000
    buffer_load_dwordx4 v[64:67], v3, s[56:59], s12 offen
    s_add_u32 s12, s12, 28672
    buffer_load_dwordx4 v[68:71], v3, s[56:59], s12 offen
    s_add_u32 s12, s12, 28672
    buffer_load_dwordx4 v[72:75], v3, s[56:59], s12 offen
    s_add_u32 s12, s12, 28672
    buffer_load_dwordx4 v[76:79], v3, s[56:59], s12 offen
    s_add_u32 s12, s12, 28672
    buffer_load_dwordx4 v[80:83], v3, s[56:59], s12 offen
    s_add_u32 s12, s12, 28672
    buffer_load_dwordx4 v[84:87], v3, s[56:59], s12 offen
    s_add_u32 s12, s12, 28672
    buffer_load_dwordx4 v[88:91], v3, s[56:59], s12 offen
    s_add_u32 s12, s12, 28672
    buffer_load_dwordx4 v[92:95], v3, s[56:59], s12 offen
    s_add_u32 s12, s12, 28672
    buffer_load_dwordx4 v[96:99], v3, s[56:59], s12 offen
    s_add_u32 s12, s12, 28672
    buffer_load_dwordx4 v[100:103], v3, s[56:59], s12 offen
    s_add_u32 s12, s12, 28672
    buffer_load_dwordx4 v[104:107], v3, s[56:59], s12 offen
    s_add_u32 s12, s12, 28672
    buffer_load_dwordx4 v[108:111], v3, s[56:59], s12 offen
    s_add_u32 s12, s12, 28672
    buffer_load_dwordx4 v[112:115], v3, s[56:59], s12 offen
    s_add_u32 s12, s12, 28672
    buffer_load_dwordx4 v[116:119], v3, s[56:59], s12 offen
    s_mov_b32 s64, s48
    s_and_b32 s65, s49, 0xffff
    s_mov_b32 s66, 33554432
    s_mov_b32 s67, 0x20000
    s_mov_b32 s60, s40
    s_and_b32 s61, s41, 0xffff
    s_mov_b32 s62, 1605632
    s_mov_b32 s63, 0x20000
    v_lshlrev_b32 v1, 2, v0
    v_add_u32 v1, 158848, v1
    v_mov_b32 v2, 157696
    v_cmp_eq_u32 vcc, 0, v0
    s_nop 1
    v_cndmask_b32 v1, v1, v2, vcc
    v_mov_b32 v2, 1
    s_lshl_b32 s8, s7, 11
    v_lshl_add_u32 v4, v0, 5, s8
    v_lshlrev_b32 v5, 2, v0
    s_waitcnt vmcnt(13)
    v_dot2_f32_bf16 v32, v64, v26, 0
    v_dot2_f32_bf16 v33, v64, v27, 0
    v_dot2_f32_bf16 v34, v65, v26, 0
    v_dot2_f32_bf16 v35, v65, v27, 0
    v_dot2_f32_bf16 v36, v66, v26, 0
    v_dot2_f32_bf16 v37, v66, v27, 0
    v_dot2_f32_bf16 v38, v67, v26, 0
    v_dot2_f32_bf16 v39, v67, v27, 0
    s_waitcnt vmcnt(12)
    v_dot2_f32_bf16 v32, v68, v26, v32
    v_dot2_f32_bf16 v33, v68, v27, v33
    v_dot2_f32_bf16 v34, v69, v26, v34
    v_dot2_f32_bf16 v35, v69, v27, v35
    v_dot2_f32_bf16 v36, v70, v26, v36
    v_dot2_f32_bf16 v37, v70, v27, v37
    v_dot2_f32_bf16 v38, v71, v26, v38
    v_dot2_f32_bf16 v39, v71, v27, v39
    s_waitcnt vmcnt(11)
    v_dot2_f32_bf16 v32, v72, v26, v32
    v_dot2_f32_bf16 v33, v72, v27, v33
    v_dot2_f32_bf16 v34, v73, v26, v34
    v_dot2_f32_bf16 v35, v73, v27, v35
    v_dot2_f32_bf16 v36, v74, v26, v36
    v_dot2_f32_bf16 v37, v74, v27, v37
    v_dot2_f32_bf16 v38, v75, v26, v38
    v_dot2_f32_bf16 v39, v75, v27, v39
    s_waitcnt vmcnt(10)
    v_dot2_f32_bf16 v32, v76, v26, v32
    v_dot2_f32_bf16 v33, v76, v27, v33
    v_dot2_f32_bf16 v34, v77, v26, v34
    v_dot2_f32_bf16 v35, v77, v27, v35
    v_dot2_f32_bf16 v36, v78, v26, v36
    v_dot2_f32_bf16 v37, v78, v27, v37
    v_dot2_f32_bf16 v38, v79, v26, v38
    v_dot2_f32_bf16 v39, v79, v27, v39
    s_waitcnt vmcnt(9)
    v_dot2_f32_bf16 v32, v80, v26, v32
    v_dot2_f32_bf16 v33, v80, v27, v33
    v_dot2_f32_bf16 v34, v81, v26, v34
    v_dot2_f32_bf16 v35, v81, v27, v35
    v_dot2_f32_bf16 v36, v82, v26, v36
    v_dot2_f32_bf16 v37, v82, v27, v37
    v_dot2_f32_bf16 v38, v83, v26, v38
    v_dot2_f32_bf16 v39, v83, v27, v39
    s_waitcnt vmcnt(8)
    v_dot2_f32_bf16 v32, v84, v26, v32
    v_dot2_f32_bf16 v33, v84, v27, v33
    v_dot2_f32_bf16 v34, v85, v26, v34
    v_dot2_f32_bf16 v35, v85, v27, v35
    v_dot2_f32_bf16 v36, v86, v26, v36
    v_dot2_f32_bf16 v37, v86, v27, v37
    v_dot2_f32_bf16 v38, v87, v26, v38
    v_dot2_f32_bf16 v39, v87, v27, v39
    s_waitcnt vmcnt(7)
    v_dot2_f32_bf16 v32, v88, v26, v32
    v_dot2_f32_bf16 v33, v88, v27, v33
    v_dot2_f32_bf16 v34, v89, v26, v34
    v_dot2_f32_bf16 v35, v89, v27, v35
    v_dot2_f32_bf16 v36, v90, v26, v36
    v_dot2_f32_bf16 v37, v90, v27, v37
    v_dot2_f32_bf16 v38, v91, v26, v38
    v_dot2_f32_bf16 v39, v91, v27, v39
    s_barrier
    s_waitcnt vmcnt(6)
    v_dot2_f32_bf16 v32, v92, v26, v32
    v_dot2_f32_bf16 v33, v92, v27, v33
    v_dot2_f32_bf16 v34, v93, v26, v34
    v_dot2_f32_bf16 v35, v93, v27, v35
    v_dot2_f32_bf16 v36, v94, v26, v36
    v_dot2_f32_bf16 v37, v94, v27, v37
    v_dot2_f32_bf16 v38, v95, v26, v38
    v_dot2_f32_bf16 v39, v95, v27, v39
    s_waitcnt vmcnt(5)
    v_dot2_f32_bf16 v32, v96, v26, v32
    v_dot2_f32_bf16 v33, v96, v27, v33
    v_dot2_f32_bf16 v34, v97, v26, v34
    v_dot2_f32_bf16 v35, v97, v27, v35
    v_dot2_f32_bf16 v36, v98, v26, v36
    v_dot2_f32_bf16 v37, v98, v27, v37
    v_dot2_f32_bf16 v38, v99, v26, v38
    v_dot2_f32_bf16 v39, v99, v27, v39
    s_waitcnt vmcnt(4)
    v_dot2_f32_bf16 v32, v100, v26, v32
    v_dot2_f32_bf16 v33, v100, v27, v33
    v_dot2_f32_bf16 v34, v101, v26, v34
    v_dot2_f32_bf16 v35, v101, v27, v35
    v_dot2_f32_bf16 v36, v102, v26, v36
    v_dot2_f32_bf16 v37, v102, v27, v37
    v_dot2_f32_bf16 v38, v103, v26, v38
    v_dot2_f32_bf16 v39, v103, v27, v39
    s_waitcnt vmcnt(3)
    v_dot2_f32_bf16 v32, v104, v26, v32
    v_dot2_f32_bf16 v33, v104, v27, v33
    v_dot2_f32_bf16 v34, v105, v26, v34
    v_dot2_f32_bf16 v35, v105, v27, v35
    v_dot2_f32_bf16 v36, v106, v26, v36
    v_dot2_f32_bf16 v37, v106, v27, v37
    v_dot2_f32_bf16 v38, v107, v26, v38
    v_dot2_f32_bf16 v39, v107, v27, v39
    s_waitcnt vmcnt(2)
    v_dot2_f32_bf16 v32, v108, v26, v32
    v_dot2_f32_bf16 v33, v108, v27, v33
    v_dot2_f32_bf16 v34, v109, v26, v34
    v_dot2_f32_bf16 v35, v109, v27, v35
    v_dot2_f32_bf16 v36, v110, v26, v36
    v_dot2_f32_bf16 v37, v110, v27, v37
    v_dot2_f32_bf16 v38, v111, v26, v38
    v_dot2_f32_bf16 v39, v111, v27, v39
    s_waitcnt vmcnt(1)
    v_dot2_f32_bf16 v32, v112, v26, v32
    v_dot2_f32_bf16 v33, v112, v27, v33
    v_dot2_f32_bf16 v34, v113, v26, v34
    v_dot2_f32_bf16 v35, v113, v27, v35
    v_dot2_f32_bf16 v36, v114, v26, v36
    v_dot2_f32_bf16 v37, v114, v27, v37
    v_dot2_f32_bf16 v38, v115, v26, v38
    v_dot2_f32_bf16 v39, v115, v27, v39
    s_waitcnt vmcnt(0)
    v_dot2_f32_bf16 v32, v116, v26, v32
    v_dot2_f32_bf16 v33, v116, v27, v33
    v_dot2_f32_bf16 v34, v117, v26, v34
    v_dot2_f32_bf16 v35, v117, v27, v35
    v_dot2_f32_bf16 v36, v118, v26, v36
    v_dot2_f32_bf16 v37, v118, v27, v37
    v_dot2_f32_bf16 v38, v119, v26, v38
    v_dot2_f32_bf16 v39, v119, v27, v39
    ds_write_b128 v4, v[32:35]
    s_nop 1
    ds_write_b128 v4, v[36:39] offset:16
    ds_add_u32 v1, v2 offset:96
    ds_read_b32 v3, v1 offset:128
    s_waitcnt lgkmcnt(0)
    v_readfirstlane_b32 s6, v3
    v_min_u32 v22, 1, v0
    v_lshlrev_b32 v22, 30, v22
    v_mov_b32 v23, s6
    s_cmp_lg_u32 s7, 0
    s_cbranch_scc1 L_SHX
    s_setprio 3
Lw_19:
    ds_read_b32 v3, v1 offset:96
    s_waitcnt lgkmcnt(0)
    v_readfirstlane_b32 s8, v3
    s_cmp_ge_u32 s8, 4
    s_cbranch_scc0 Lw_19r
    ds_read_b32 v64, v5 offset:0
    ds_read_b32 v65, v5 offset:256
    ds_read_b32 v66, v5 offset:512
    ds_read_b32 v67, v5 offset:768
    ds_read_b32 v68, v5 offset:1024
    ds_read_b32 v69, v5 offset:1280
    ds_read_b32 v70, v5 offset:1536
    ds_read_b32 v71, v5 offset:1792
    ds_read_b32 v72, v5 offset:2048
    ds_read_b32 v73, v5 offset:2304
    ds_read_b32 v74, v5 offset:2560
    ds_read_b32 v75, v5 offset:2816
    ds_read_b32 v76, v5 offset:3072
    ds_read_b32 v77, v5 offset:3328
    ds_read_b32 v78, v5 offset:3584
    ds_read_b32 v79, v5 offset:3840
    ds_read_b32 v80, v5 offset:4096
    ds_read_b32 v81, v5 offset:4352
    ds_read_b32 v82, v5 offset:4608
    ds_read_b32 v83, v5 offset:4864
    ds_read_b32 v84, v5 offset:5120
    ds_read_b32 v85, v5 offset:5376
    ds_read_b32 v86, v5 offset:5632
    ds_read_b32 v87, v5 offset:5888
    ds_read_b32 v88, v5 offset:6144
    ds_read_b32 v89, v5 offset:6400
    ds_read_b32 v90, v5 offset:6656
    ds_read_b32 v91, v5 offset:6912
    ds_read_b32 v92, v5 offset:7168
    ds_read_b32 v93, v5 offset:7424
    ds_read_b32 v94, v5 offset:7680
    ds_read_b32 v95, v5 offset:7936
    s_waitcnt lgkmcnt(0)
    v_add_f32 v64, v64, v80
    v_add_f32 v65, v65, v81
    v_add_f32 v66, v66, v82
    v_add_f32 v67, v67, v83
    v_add_f32 v68, v68, v84
    v_add_f32 v69, v69, v85
    v_add_f32 v70, v70, v86
    v_add_f32 v71, v71, v87
    v_add_f32 v72, v72, v88
    v_add_f32 v73, v73, v89
    v_add_f32 v74, v74, v90
    v_add_f32 v75, v75, v91
    v_add_f32 v76, v76, v92
    v_add_f32 v77, v77, v93
    v_add_f32 v78, v78, v94
    v_add_f32 v79, v79, v95
    v_add_f32 v64, v64, v72
    v_add_f32 v65, v65, v73
    v_add_f32 v66, v66, v74
    v_add_f32 v67, v67, v75
    v_add_f32 v68, v68, v76
    v_add_f32 v69, v69, v77
    v_add_f32 v70, v70, v78
    v_add_f32 v71, v71, v79
    v_add_f32 v64, v64, v68
    v_add_f32 v65, v65, v69
    v_add_f32 v66, v66, v70
    v_add_f32 v67, v67, v71
    v_add_f32 v64, v64, v66
    v_add_f32 v65, v65, v67
    v_add_f32 v64, v64, v65
    v_cvt_pk_bf16_f32 v65, v64, v64
    v_and_b32 v65, 0xffff0000, v65
    v_sub_f32 v66, v64, v65
    v_cvt_pk_bf16_f32 v64, v65, v66
    v_mov_b32 v65, s6
    v_lshlrev_b32 v4, 3, v0
    s_lshl_b32 s8, s11, 9
    s_add_u32 s8, s8, 32768
    buffer_store_dwordx2 v[64:65], v4, s[64:67], s8 offen sc1
    s_mov_b64 exec, -1
    s_branch L_HP
L_SHX:
    s_lshl_b32 s8, s4, 2
    s_add_u32 s8, s8, s5
    s_lshl_b32 s9, s3, 5
    s_add_u32 s8, s8, s9
    s_cmp_ge_u32 s8, 256
    s_cbranch_scc1 L_HP
    s_lshl_b32 s30, s4, 2
    s_add_u32 s30, s30, s5
    s_sub_u32 s30, s30, 28
    s_lshl_b32 s8, s3, 5
    s_add_u32 s30, s30, s8
    s_cmp_gt_u32 s3, 4
    s_cselect_b32 s8, 32, 0
    s_sub_u32 s30, s30, s8
    s_min_u32 s30, s30, 195
    s_mul_i32 s8, s30, 2341
    s_lshr_b32 s8, s8, 16
    s_mul_i32 s9, s8, 28
    s_sub_u32 s9, s30, s9
    s_mul_i32 s31, s9, 9363
    s_lshr_b32 s31, s31, 16
    s_mul_i32 s31, s31, 7
    s_add_u32 s31, s31, s9
    s_mul_i32 s31, s31, 28672
    s_lshl_b32 s8, s8, 7
    s_add_u32 s31, s31, s8
    v_lshrrev_b32 v40, 3, v0
    v_and_b32 v41, 7, v0
    v_mul_u32_u24 v40, 896, v40
    v_bfe_u32 v42, v0, 4, 1
    v_lshlrev_b32 v42, 2, v42
    v_xor_b32 v42, v42, v41
    v_lshl_add_u32 v40, v42, 4, v40
    s_lshl_b32 s34, s3, 12
    s_add_u32 s34, s34, 16384
    s_mov_b32 m0, s34
    s_nop 0
    buffer_load_dwordx4 v40, s[60:63], s31 offen offset:0 lds
    s_add_u32 s31, s31, 6144
    buffer_load_dwordx4 v40, s[60:63], s31 offen offset:1024 lds
    s_add_u32 s31, s31, 6144
    buffer_load_dwordx4 v40, s[60:63], s31 offen offset:2048 lds
    s_add_u32 s31, s31, 6144
    buffer_load_dwordx4 v40, s[60:63], s31 offen offset:3072 lds
    v_bfe_u32 v40, v0, 2, 2
    v_and_b32 v41, 3, v0
    v_lshrrev_b32 v42, 5, v0
    v_bfe_u32 v43, v0, 4, 1
    v_lshlrev_b32 v43, 5, v43
    v_lshl_add_u32 v43, v41, 3, v43
    v_lshl_add_u32 v42, v42, 2, v40
    v_lshl_add_u32 v42, v42, 7, v43
    v_add_u32 v42, s34, v42
    v_lshrrev_b32 v40, 1, v40
    v_lshl_add_u32 v42, v40, 6, v42
    v_xor_b32 v43, 64, v42
    v_lshlrev_b32 v44, 4, v0
    s_mul_i32 s8, s30, 9363
    s_lshr_b32 s8, s8, 16
    s_mul_i32 s9, s8, 7
    s_sub_u32 s9, s30, s9
    s_mul_i32 s31, s9, 114688
    s_lshl_b32 s8, s8, 7
    s_add_u32 s31, s31, s8
    s_add_u32 s31, s31, 3145728
    s_lshl_b32 s30, s30, 7
    s_add_u32 s30, s30, 458752
    v_lshrrev_b32 v44, 3, v0
    v_mul_u32_u24 v44, 3584, v44
    v_and_b32 v45, 7, v0
    v_lshl_add_u32 v44, v45, 4, v44
    s_waitcnt vmcnt(0)
    ds_read_b64_tr_b16 v[128:129], v42 offset:0
    ds_read_b64_tr_b16 v[130:131], v42 offset:1024
    ds_read_b64_tr_b16 v[132:133], v43 offset:0
    ds_read_b64_tr_b16 v[134:135], v43 offset:1024
    ds_read_b64_tr_b16 v[136:137], v42 offset:2048
    ds_read_b64_tr_b16 v[138:139], v42 offset:3072
    ds_read_b64_tr_b16 v[140:141], v43 offset:2048
    ds_read_b64_tr_b16 v[142:143], v43 offset:3072
    s_waitcnt lgkmcnt(6)
    buffer_store_dwordx4 v[128:131], v44, s[64:67], s31 offen sc1
    s_add_u32 s31, s31, 28672
    s_waitcnt lgkmcnt(4)
    buffer_store_dwordx4 v[132:135], v44, s[64:67], s31 offen sc1
    s_add_u32 s31, s31, 28672
    s_waitcnt lgkmcnt(2)
    buffer_store_dwordx4 v[136:139], v44, s[64:67], s31 offen sc1
    s_add_u32 s31, s31, 28672
    s_waitcnt lgkmcnt(0)
    buffer_store_dwordx4 v[140:143], v44, s[64:67], s31 offen sc1
    s_add_u32 s31, s31, 28672
    v_lshrrev_b32 v22, 5, v0
    v_lshlrev_b32 v22, 30, v22
    v_lshl_add_u32 v22, v0, 2, v22
    v_and_b32 v45, 31, v0
    v_lshlrev_b32 v45, 7, v45
    s_waitcnt vmcnt(0)
    buffer_store_dword v23, v22, s[64:67], s30 offen sc1
    s_mov_b64 exec, -1
L_HP:
    s_setprio 0
    s_sub_u32 s10, s5, 28
    v_min_u32 v19, 6, v0
    v_lshlrev_b32 v19, 7, v19
    v_lshlrev_b32 v4, 7, v0
    s_endpgm
La_7s:
    s_sleep 12
    buffer_load_dword v12, v11, s[64:67], s15 offen sc1
    s_waitcnt vmcnt(0)
    s_branch La_7r
La_16s:
    s_sleep 8
    buffer_load_dwordx2 v[80:81], v56, s[64:67], s18 offen sc1
    s_waitcnt vmcnt(0)
    s_branch La_16r
Lw_8r:
    s_add_u32 s100, s100, 1
    s_cmp_lt_u32 s100, 400000
    s_cbranch_scc1 Lw_8
    s_endpgm
Lw_11r:
    s_add_u32 s100, s100, 1
    s_cmp_lt_u32 s100, 400000
    s_cbranch_scc1 Lw_11
    s_endpgm
Lw_14r:
    s_add_u32 s100, s100, 1
    s_cmp_lt_u32 s100, 400000
    s_cbranch_scc1 Lw_14
    s_endpgm
Lw_15r:
    s_add_u32 s100, s100, 1
    s_cmp_lt_u32 s100, 400000
    s_cbranch_scc1 Lw_15
    s_endpgm
Lw_17r:
    s_sleep 2
    s_add_u32 s100, s100, 1
    s_cmp_lt_u32 s100, 400000
    s_cbranch_scc1 Lw_17
    s_endpgm
Lp_18r:
    s_sleep 8
    s_add_u32 s100, s100, 1
    s_cmp_lt_u32 s100, 400000
    s_cbranch_scc1 Lp_18
    s_endpgm
Lw_19r:
    s_add_u32 s100, s100, 1
    s_cmp_lt_u32 s100, 400000
    s_cbranch_scc1 Lw_19
    s_endpgm
La_7r:
    s_add_u32 s100, s100, 1
    s_cmp_lt_u32 s100, 400000
    s_cbranch_scc1 La_7
    s_endpgm
La_16r:
    s_add_u32 s100, s100, 1
    s_cmp_lt_u32 s100, 400000
    s_cbranch_scc1 La_16
    s_endpgm
L_end:
    s_endpgm
.section .rodata,"a"
.p2align 6
.amdhsa_kernel parallel_sum__ssm_conv_s4__dense_activation_squared_relu__prompt_kernel
  .amdhsa_next_free_vgpr 256
  .amdhsa_next_free_sgpr 102
  .amdhsa_accum_offset 256
  .amdhsa_group_segment_fixed_size 0
  .amdhsa_kernarg_size 136
  .amdhsa_user_sgpr_count 2
  .amdhsa_user_sgpr_kernarg_segment_ptr 1
  .amdhsa_system_sgpr_workgroup_id_x 1
.end_amdhsa_kernel
```
